```python
import torch

def _softmax(x, axis=-1):
    return torch.softmax(x, dim=axis)

def _gelu(x):
    return torch.nn.functional.gelu(x, approximate='tanh')

def _silu(x):
    return torch.nn.functional.silu(x)

def _sigmoid(x):
    return torch.sigmoid(x)

def _layernorm(x, axis=-1, eps=1e-05):
    m = x.mean(dim=axis, keepdim=True)
    v = x.var(dim=axis, keepdim=True, unbiased=False)
    return (x - m) / torch.sqrt(v + eps)

def _scatter_add(tgt, idx, src, axis=0):
    return tgt.clone().index_add_(axis, idx, src)

def _segment_sum(src, seg, n):
    out = torch.zeros((n,) + src.shape[1:], dtype=src.dtype)
    return out.index_add_(0, seg, src)

def _pad(x, pw):
    flat = tuple((v for pair in reversed(pw) for v in pair))
    return torch.nn.functional.pad(x, flat)
kernel_name = 'adaLN_cond__sliding_block_cached__geglu_ffn__decode'

def setup_inputs():

    _w = lambda a: (lambda t: t.to(torch.bfloat16) if t.is_floating_point() else t)(torch.as_tensor(a))

    def _A_setup():
        B, Sq, D = (2, 1, 640)
        Hq, Hkv, Sk, Dh = (32, 32, 4096, 192)
        assert Hq % Hkv == 0, (Hq, Hkv)
        return {'x': _w((lambda *s: torch.randn(*s, dtype=torch.bfloat16) * 0.05)(B, Sq, D)), 'k_cache': _w((lambda *s: torch.randn(*s, dtype=torch.bfloat16) * 3.2)(B, Hkv, Sk, Dh)), 'v_cache': _w((lambda *s: torch.randn(*s, dtype=torch.bfloat16) * 0.4)(B, Hkv, Sk, Dh)), 'wq': _w((lambda *s: torch.randn(*s, dtype=torch.bfloat16) * 3.2)(D, Hq * Dh) * D ** (-0.5)), 'wo': _w((lambda *s: torch.randn(*s, dtype=torch.bfloat16) * 0.4)(Hq * Dh, D) * (Hq * Dh) ** (-0.5))}
    _A_in = _A_setup()

    def _B_setup():
        B, S, D, F = (2, 1, 640, 1536)
        return {'x': _w((lambda *s: torch.randn(*s, dtype=torch.bfloat16) * 0.05)(B, S, D)), 'w_gate': _w((lambda *s: torch.randn(*s, dtype=torch.bfloat16) * 0.05)(D, F)), 'w_up': _w((lambda *s: torch.randn(*s, dtype=torch.bfloat16) * 0.05)(D, F)), 'w_down': _w((lambda *s: torch.randn(*s, dtype=torch.bfloat16) * 0.05)(F, D))}
    _B_in = _B_setup()
    return {'A_x': _A_in['x'], 'A_k_cache': _A_in['k_cache'], 'A_v_cache': _A_in['v_cache'], 'A_wq': _A_in['wq'], 'A_wo': _A_in['wo'], 'B_x': _B_in['x'], 'B_w_gate': _B_in['w_gate'], 'B_w_up': _B_in['w_up'], 'B_w_down': _B_in['w_down'], 'c': _w((lambda *s: torch.randn(*s, dtype=torch.bfloat16) * 0.1)(2, 640) * 8.0), 'w_mod': _w((lambda *s: torch.randn(*s, dtype=torch.bfloat16) * 0.1)(640, 6 * 640) * 640 ** (-0.5) * 8.0)}

def reference(A_x, A_k_cache, A_v_cache, A_wq, A_wo, B_x, B_w_gate, B_w_up, B_w_down, c, w_mod):

    def _A_ref(x, k_cache, v_cache, wq, wo):
        B, Sq, D = x.shape
        Hq, Dh = (32, 192)
        Hkv, Sk = (k_cache.shape[1], k_cache.shape[2])
        W = min(4096, max(256, Sk // 4))
        rep = Hq // Hkv
        q = (lambda x, *d: x.permute(*d))((x @ wq).reshape(B, Sq, Hq, Dh), 0, 2, 1, 3)
        k = (lambda x, n, axis: torch.repeat_interleave(x, n, dim=axis))(k_cache[:, :, Sk - W:, :], rep, axis=1)
        v = (lambda x, n, axis: torch.repeat_interleave(x, n, dim=axis))(v_cache[:, :, Sk - W:, :], rep, axis=1)
        scores = torch.einsum('bhqd,bhkd->bhqk', q, k) * Dh ** (-0.5)
        p = _softmax(scores, axis=-1)
        o = torch.einsum('bhqk,bhkd->bhqd', p, v)
        return (lambda x, *d: x.permute(*d))(o, 0, 2, 1, 3).reshape(B, Sq, Hq * Dh) @ wo

    def _B_ref(x, w_gate, w_up, w_down):
        return _gelu(x @ w_gate) * (x @ w_up) @ w_down
    x = A_x
    mod = (_silu(c) @ w_mod).reshape(c.shape[0], 6, 1, -1)
    sa, ca, ga, sb, cb, gb = (mod[:, 0].clone(), mod[:, 1].clone(), mod[:, 2].clone(), mod[:, 3].clone(), mod[:, 4].clone(), mod[:, 5].clone())
    h = _layernorm(x, axis=-1) * (1 + ca) + sa
    x = x + ga * _A_ref(h, A_k_cache, A_v_cache, A_wq, A_wo)
    h = _layernorm(x, axis=-1) * (1 + cb) + sb
    x = x + gb * _B_ref(h, B_w_gate, B_w_up, B_w_down)
    return x
```

```asm
; @launch grid=(256,1,1) block=(640,1,1) lds=154624
.amdgcn_target "amdgcn-amd-amdhsa--gfx950"
.text
.globl adaLN_cond__sliding_block_cached__geglu_ffn__decode_kernel
.p2align 8
.type adaLN_cond__sliding_block_cached__geglu_ffn__decode_kernel,@function
adaLN_cond__sliding_block_cached__geglu_ffn__decode_kernel:
s_cmp_ge_u32 s2, 256
s_cbranch_scc1 L_exit
s_load_dwordx16 s[76:91], s[0:1], 0
s_load_dwordx8 s[64:71], s[0:1], 64
s_load_dwordx2 s[10:11], s[0:1], 104
v_lshrrev_b32 v1, 6, v0
v_and_b32 v0, 63, v0
v_readfirstlane_b32 s4, v1
s_mov_b32 s95, 0
s_and_b32 s5, s2, 7
s_lshr_b32 s6, s2, 3
s_cmp_ge_u32 s4, 8
s_cbranch_scc1 L_F
s_getpc_b64 s[56:57]
L_tp_1:
s_add_u32 s56, s56, L_table-L_tp_1
s_addc_u32 s57, s57, 0
s_lshr_b32 s53, s6, 1
s_lshl_b32 s53, s53, 2
s_mov_b32 s54, 0x4a
s_lshr_b32 s54, s54, s5
s_and_b32 s54, s54, 1
s_lshl_b32 s55, s54, 6
s_add_u32 s53, s53, s55
s_load_dword s52, s[56:57], s53
v_lshrrev_b32 v1, 3, v0
v_mul_u32_u24 v1, 384, v1
v_and_b32 v2, 7, v0
v_lshlrev_b32 v2, 4, v2
v_add_u32 v1, v1, v2
s_waitcnt lgkmcnt(0)
s_load_dword s7, s[10:11], 0
s_mov_b64 s[12:13], s[78:79]
s_mov_b64 s[14:15], s[80:81]
s_mov_b64 s[44:45], s[76:77]
s_mov_b64 s[46:47], s[70:71]
s_mov_b64 s[48:49], s[64:65]
s_and_b32 s53, s6, 1
s_lshl_b32 s53, s53, 4
s_lshr_b32 s52, s52, s53
s_and_b32 s52, s52, 0xffff
s_and_b32 s20, s52, 7
s_lshr_b32 s21, s20, 2
s_and_b32 s22, s20, 3
s_lshl_b32 s21, s21, 5
s_add_u32 s21, s21, s22
s_lshl_b32 s22, s5, 2
s_add_u32 s21, s21, s22
s_lshl_b32 s21, s21, 12
s_add_u32 s21, s21, 3072
s_lshr_b32 s22, s52, 8
s_lshl_b32 s22, s22, 6
s_add_u32 s21, s21, s22
s_bfe_u32 s58, s52, 0x30005
s_lshl_b32 s22, s58, 3
s_mul_i32 s22, s22, s4
s_add_u32 s21, s21, s22
s_mul_i32 s27, s21, 384
s_mul_i32 s18, s58, 3072
s_add_u32 s16, s12, s27
s_addc_u32 s17, s13, 0
s_mov_b32 s19, 0x20000
s_add_u32 s20, s14, s27
s_addc_u32 s21, s15, 0
s_mov_b32 s22, s18
s_mov_b32 s23, 0x20000
s_sub_u32 s24, s18, 15360
s_add_u32 s25, s24, 3072
s_add_u32 s26, s25, 3072
s_add_u32 s27, s26, 3072
s_add_u32 s28, s27, 3072
s_mov_b32 s72, s10
s_mov_b32 s73, s11
s_mov_b32 s74, 0x200000
s_mov_b32 s75, 0x20000
s_bfe_u32 s59, s52, 0x50000
s_and_b32 s3, s59, 7
s_lshl_b32 s3, s3, 2
s_lshr_b32 s59, s59, 3
s_add_u32 s59, s59, s3
s_lshl_b32 s3, s5, 5
s_add_u32 s59, s59, s3
s_lshl_b32 s59, s59, 10
s_add_u32 s59, s59, 327680
s_mov_b32 s60, 0
buffer_load_dword v164, v1, s[20:23], s28 offen
s_cmp_ge_u32 s6, 10
s_cbranch_scc0 L_tl
s_cmp_lt_u32 s6, 16
s_cbranch_scc0 L_tl
v_lshlrev_b32 v165, 2, v0
global_load_dword v165, v165, s[48:49]
v_lshlrev_b32 v167, 2, v0
global_load_dword v167, v167, s[46:47]
L_tl:
s_cmp_ge_u32 s6, 16
s_cbranch_scc1 L_A_light
s_cmp_ge_u32 s6, 10
s_cbranch_scc1 L_A_ffn
v_and_b32 v6, 7, v0
v_lshlrev_b32 v6, 4, v6
v_add_u32 v6, 122880, v6
v_mov_b32 v159, 123480
s_waitcnt vmcnt(1)
buffer_load_dwordx4 v[16:19], v1, s[16:19], s24 offen offset:0 nt
s_barrier
s_waitcnt vmcnt(1)
buffer_load_dwordx4 v[20:23], v1, s[16:19], s24 offen offset:128 nt
s_waitcnt vmcnt(1)
buffer_load_dwordx4 v[24:27], v1, s[16:19], s24 offen offset:256 nt
s_waitcnt vmcnt(1)
buffer_load_dwordx4 v[28:31], v1, s[16:19], s25 offen offset:0 nt
s_waitcnt vmcnt(1)
buffer_load_dwordx4 v[32:35], v1, s[16:19], s25 offen offset:128 nt
s_waitcnt vmcnt(1)
buffer_load_dwordx4 v[36:39], v1, s[16:19], s25 offen offset:256 nt
s_waitcnt vmcnt(1)
buffer_load_dwordx4 v[40:43], v1, s[16:19], s26 offen offset:0 nt
s_waitcnt vmcnt(1)
buffer_load_dwordx4 v[44:47], v1, s[16:19], s26 offen offset:128 nt
s_waitcnt vmcnt(1)
buffer_load_dwordx4 v[48:51], v1, s[16:19], s26 offen offset:256 nt
s_waitcnt vmcnt(1)
buffer_load_dwordx4 v[52:55], v1, s[16:19], s27 offen offset:0 nt
s_waitcnt vmcnt(1)
buffer_load_dwordx4 v[56:59], v1, s[16:19], s27 offen offset:128 nt
s_waitcnt vmcnt(1)
buffer_load_dwordx4 v[60:63], v1, s[16:19], s27 offen offset:256 nt
s_waitcnt vmcnt(2)
buffer_load_dwordx4 v[64:67], v1, s[16:19], s28 offen offset:0 nt
s_waitcnt vmcnt(2)
buffer_load_dwordx4 v[68:71], v1, s[16:19], s28 offen offset:128 nt
s_waitcnt vmcnt(2)
buffer_load_dwordx4 v[72:75], v1, s[16:19], s28 offen offset:256 nt
s_waitcnt vmcnt(2)
buffer_load_dwordx4 v[76:79], v1, s[20:23], s24 offen offset:0 nt
s_waitcnt vmcnt(2)
buffer_load_dwordx4 v[80:83], v1, s[20:23], s24 offen offset:128 nt
s_waitcnt vmcnt(2)
buffer_load_dwordx4 v[84:87], v1, s[20:23], s24 offen offset:256 nt
s_waitcnt vmcnt(2)
buffer_load_dwordx4 v[88:91], v1, s[20:23], s25 offen offset:0 nt
s_waitcnt vmcnt(2)
buffer_load_dwordx4 v[92:95], v1, s[20:23], s25 offen offset:128 nt
s_waitcnt vmcnt(2)
buffer_load_dwordx4 v[96:99], v1, s[20:23], s25 offen offset:256 nt
s_waitcnt vmcnt(2)
buffer_load_dwordx4 v[100:103], v1, s[20:23], s26 offen offset:0 nt
s_waitcnt vmcnt(2)
buffer_load_dwordx4 v[104:107], v1, s[20:23], s26 offen offset:128 nt
s_waitcnt vmcnt(2)
buffer_load_dwordx4 v[108:111], v1, s[20:23], s26 offen offset:256 nt
ds_read_b32 v7, v159
s_waitcnt lgkmcnt(0)
v_readfirstlane_b32 s60, v7
s_nop 1
s_cmp_eq_u32 s60, 1
s_cbranch_scc0 L_qW
ds_read_b128 v[8:11], v6
ds_read_b128 v[12:15], v6 offset:128
ds_read_b128 v[160:163], v6 offset:256
s_waitcnt lgkmcnt(0)
L_qW:
buffer_load_dwordx4 v[112:115], v1, s[20:23], s27 offen offset:0 nt
buffer_load_dwordx4 v[116:119], v1, s[20:23], s27 offen offset:128 nt
buffer_load_dwordx4 v[120:123], v1, s[20:23], s27 offen offset:256 nt
buffer_load_dwordx4 v[124:127], v1, s[20:23], s28 offen offset:0 nt
buffer_load_dwordx4 v[128:131], v1, s[20:23], s28 offen offset:128 nt
buffer_load_dwordx4 v[132:135], v1, s[20:23], s28 offen offset:256 nt
s_branch L_A_hv
L_A_ffn:
v_and_b32 v6, 7, v0
v_lshlrev_b32 v6, 4, v6
v_add_u32 v6, 122880, v6
v_mov_b32 v159, 123480
s_barrier
s_cmp_eq_u32 s58, 2
s_cbranch_scc1 L_A_fK3
s_cmp_eq_u32 s58, 4
s_cbranch_scc1 L_A_fK1
s_waitcnt vmcnt(0)
buffer_load_dwordx4 v[16:19], v1, s[16:19], s24 offen offset:0 nt
s_waitcnt vmcnt(0)
buffer_load_dwordx4 v[20:23], v1, s[16:19], s24 offen offset:128 nt
s_waitcnt vmcnt(0)
buffer_load_dwordx4 v[24:27], v1, s[16:19], s24 offen offset:256 nt
L_A_fK1:
s_waitcnt vmcnt(0)
buffer_load_dwordx4 v[28:31], v1, s[16:19], s25 offen offset:0 nt
s_waitcnt vmcnt(0)
buffer_load_dwordx4 v[32:35], v1, s[16:19], s25 offen offset:128 nt
s_waitcnt vmcnt(0)
buffer_load_dwordx4 v[36:39], v1, s[16:19], s25 offen offset:256 nt
s_waitcnt vmcnt(0)
buffer_load_dwordx4 v[40:43], v1, s[16:19], s26 offen offset:0 nt
s_waitcnt vmcnt(0)
buffer_load_dwordx4 v[44:47], v1, s[16:19], s26 offen offset:128 nt
s_waitcnt vmcnt(4)
buffer_load_dwordx4 v[48:51], v1, s[16:19], s26 offen offset:256 nt
L_A_fK3:
s_waitcnt vmcnt(4)
buffer_load_dwordx4 v[52:55], v1, s[16:19], s27 offen offset:0 nt
s_waitcnt vmcnt(4)
buffer_load_dwordx4 v[56:59], v1, s[16:19], s27 offen offset:128 nt
s_waitcnt vmcnt(4)
buffer_load_dwordx4 v[60:63], v1, s[16:19], s27 offen offset:256 nt
s_waitcnt vmcnt(4)
buffer_load_dwordx4 v[64:67], v1, s[16:19], s28 offen offset:0 nt
s_waitcnt vmcnt(4)
buffer_load_dwordx4 v[68:71], v1, s[16:19], s28 offen offset:128 nt
s_waitcnt vmcnt(4)
buffer_load_dwordx4 v[72:75], v1, s[16:19], s28 offen offset:256 nt
s_cmp_eq_u32 s58, 2
s_cbranch_scc1 L_A_fV3
s_cmp_eq_u32 s58, 4
s_cbranch_scc1 L_A_fV1
s_waitcnt vmcnt(4)
buffer_load_dwordx4 v[76:79], v1, s[20:23], s24 offen offset:0 nt
s_waitcnt vmcnt(4)
buffer_load_dwordx4 v[80:83], v1, s[20:23], s24 offen offset:128 nt
s_waitcnt vmcnt(4)
buffer_load_dwordx4 v[84:87], v1, s[20:23], s24 offen offset:256 nt
L_A_fV1:
s_waitcnt vmcnt(4)
buffer_load_dwordx4 v[88:91], v1, s[20:23], s25 offen offset:0 nt
s_waitcnt vmcnt(4)
buffer_load_dwordx4 v[92:95], v1, s[20:23], s25 offen offset:128 nt
s_waitcnt vmcnt(4)
buffer_load_dwordx4 v[96:99], v1, s[20:23], s25 offen offset:256 nt
s_waitcnt vmcnt(4)
buffer_load_dwordx4 v[100:103], v1, s[20:23], s26 offen offset:0 nt
s_waitcnt vmcnt(4)
buffer_load_dwordx4 v[104:107], v1, s[20:23], s26 offen offset:128 nt
s_waitcnt vmcnt(4)
buffer_load_dwordx4 v[108:111], v1, s[20:23], s26 offen offset:256 nt
L_A_fV3:
ds_read_b32 v7, v159
s_waitcnt lgkmcnt(0)
v_readfirstlane_b32 s60, v7
s_nop 1
s_cmp_eq_u32 s60, 1
s_cbranch_scc0 L_qF
ds_read_b128 v[8:11], v6
ds_read_b128 v[12:15], v6 offset:128
ds_read_b128 v[160:163], v6 offset:256
s_waitcnt lgkmcnt(0)
L_qF:
buffer_load_dwordx4 v[112:115], v1, s[20:23], s27 offen offset:0 nt
buffer_load_dwordx4 v[116:119], v1, s[20:23], s27 offen offset:128 nt
buffer_load_dwordx4 v[120:123], v1, s[20:23], s27 offen offset:256 nt
buffer_load_dwordx4 v[124:127], v1, s[20:23], s28 offen offset:0 nt
buffer_load_dwordx4 v[128:131], v1, s[20:23], s28 offen offset:128 nt
buffer_load_dwordx4 v[132:135], v1, s[20:23], s28 offen offset:256 nt
L_A_hv:
v_and_b32 v2, 1, v0
v_mov_b32 v3, 0xffff
v_mov_b32 v4, 0xffff0000
v_cmp_eq_u32 vcc, 1, v2
s_nop 1
v_cndmask_b32 v3, v3, v4, vcc
v_bfe_u32 v2, v0, 1, 2
v_cmp_eq_u32 vcc, 0, v2
s_nop 1
v_cndmask_b32 v148, 0, v3, vcc
v_cmp_eq_u32 vcc, 1, v2
s_nop 1
v_cndmask_b32 v149, 0, v3, vcc
v_cmp_eq_u32 vcc, 2, v2
s_nop 1
v_cndmask_b32 v150, 0, v3, vcc
v_cmp_eq_u32 vcc, 3, v2
s_nop 1
v_cndmask_b32 v151, 0, v3, vcc
v_mov_b32 v5, 0xffffff00
s_waitcnt lgkmcnt(0)
s_add_u32 s7, s7, 1
s_and_b32 s8, s7, 0x7f
s_add_u32 s8, s8, 1
s_add_u32 s9, s8, 127
s_branch L_A_issued
L_A_light:
v_and_b32 v2, 1, v0
v_mov_b32 v3, 0xffff
v_mov_b32 v4, 0xffff0000
v_cmp_eq_u32 vcc, 1, v2
s_nop 1
v_cndmask_b32 v3, v3, v4, vcc
v_bfe_u32 v2, v0, 1, 2
v_cmp_eq_u32 vcc, 0, v2
s_nop 1
v_cndmask_b32 v148, 0, v3, vcc
v_cmp_eq_u32 vcc, 1, v2
s_nop 1
v_cndmask_b32 v149, 0, v3, vcc
v_cmp_eq_u32 vcc, 2, v2
s_nop 1
v_cndmask_b32 v150, 0, v3, vcc
v_cmp_eq_u32 vcc, 3, v2
s_nop 1
v_cndmask_b32 v151, 0, v3, vcc
v_mov_b32 v5, 0xffffff00
s_sub_u32 s33, s6, 16
s_cmp_lt_u32 s33, 5
s_cselect_b32 s43, 1280, 0
s_cselect_b32 s42, 3, 2
s_cmp_ge_u32 s33, 14
s_cselect_b32 s42, 3, s42
s_mov_b32 s40, 0
s_mov_b32 s41, 123904
s_mov_b32 s39, 123776
v_lshrrev_b32 v8, 4, v0
v_lshlrev_b32 v8, 3, v8
v_bfe_u32 v9, v0, 3, 1
v_lshlrev_b32 v9, 2, v9
v_add_u32 v8, v8, v9
s_mul_i32 s29, s4, 160
v_add_u32 v8, s29, v8
v_lshlrev_b32 v9, 4, v0
s_mul_i32 s29, s4, 5120
v_add_u32 v9, s29, v9
v_lshlrev_b32 v10, 4, v0
s_mul_i32 s29, s4, 1040
s_add_u32 s29, s29, 141824
v_add_u32 v10, s29, v10
v_lshrrev_b32 v12, 3, v0
s_lshl_b32 s29, s4, 3
v_add_u32 v12, s29, v12
v_and_b32 v11, 7, v0
v_mul_u32_u24 v11, 1040, v11
v_lshlrev_b32 v13, 4, v12
v_add_u32 v11, v11, v13
v_add_u32 v11, 141824, v11
v_lshrrev_b32 v13, 5, v12
v_lshlrev_b32 v13, 9, v13
v_and_b32 v14, 15, v12
v_lshlrev_b32 v14, 5, v14
v_add_u32 v13, v13, v14
v_bfe_u32 v14, v12, 4, 1
v_lshlrev_b32 v14, 4, v14
v_add_u32 v12, v13, v14
s_mov_b32 s38, 0
s_waitcnt lgkmcnt(0)
s_add_u32 s7, s7, 1
s_and_b32 s8, s7, 0x7f
s_add_u32 s8, s8, 1
s_add_u32 s9, s8, 127
s_cmp_eq_u32 s43, 0
s_cbranch_scc0 L_A_step
s_barrier
s_cmp_eq_u32 s58, 4
s_cbranch_scc0 L_A_pre3
buffer_load_dwordx4 v[28:31], v1, s[16:19], s25 offen offset:0 nt
buffer_load_dwordx4 v[32:35], v1, s[16:19], s25 offen offset:128 nt
buffer_load_dwordx4 v[36:39], v1, s[16:19], s25 offen offset:256 nt
buffer_load_dwordx4 v[40:43], v1, s[16:19], s26 offen offset:0 nt
buffer_load_dwordx4 v[44:47], v1, s[16:19], s26 offen offset:128 nt
buffer_load_dwordx4 v[48:51], v1, s[16:19], s26 offen offset:256 nt
s_branch L_A_step
L_A_pre3:
buffer_load_dwordx4 v[40:43], v1, s[16:19], s26 offen offset:0 nt
buffer_load_dwordx4 v[44:47], v1, s[16:19], s26 offen offset:128 nt
buffer_load_dwordx4 v[48:51], v1, s[16:19], s26 offen offset:256 nt
buffer_load_dwordx4 v[52:55], v1, s[16:19], s27 offen offset:0 nt
buffer_load_dwordx4 v[56:59], v1, s[16:19], s27 offen offset:128 nt
buffer_load_dwordx4 v[60:63], v1, s[16:19], s27 offen offset:256 nt
L_A_step:
s_barrier
v_add_u32 v2, s41, v8
v_add_u32 v3, s40, v9
v_mov_b32 v4, s39
ds_read_b32 v96, v2 offset:0
ds_read_b32 v97, v2 offset:32
ds_read_b32 v98, v2 offset:64
ds_read_b32 v99, v2 offset:96
ds_read_b32 v100, v2 offset:128
ds_read_b32 v101, v4
ds_read_b128 v[76:79], v3 offset:0
ds_read_b128 v[80:83], v3 offset:1024
ds_read_b128 v[84:87], v3 offset:2048
ds_read_b128 v[88:91], v3 offset:3072
ds_read_b128 v[92:95], v3 offset:4096
s_waitcnt lgkmcnt(4)
v_and_b32 v104, v96, v148
v_and_b32 v105, v96, v149
v_and_b32 v106, v96, v150
v_and_b32 v107, v96, v151
s_nop 1
v_mfma_f32_16x16x32_bf16 v[112:115], v[104:107], v[76:79], 0
s_waitcnt lgkmcnt(3)
v_and_b32 v108, v97, v148
v_and_b32 v109, v97, v149
v_and_b32 v110, v97, v150
v_and_b32 v111, v97, v151
s_nop 1
v_mfma_f32_16x16x32_bf16 v[112:115], v[108:111], v[80:83], v[112:115]
s_waitcnt lgkmcnt(2)
v_and_b32 v104, v98, v148
v_and_b32 v105, v98, v149
v_and_b32 v106, v98, v150
v_and_b32 v107, v98, v151
s_nop 1
v_mfma_f32_16x16x32_bf16 v[112:115], v[104:107], v[84:87], v[112:115]
s_waitcnt lgkmcnt(1)
v_and_b32 v108, v99, v148
v_and_b32 v109, v99, v149
v_and_b32 v110, v99, v150
v_and_b32 v111, v99, v151
s_nop 1
v_mfma_f32_16x16x32_bf16 v[112:115], v[108:111], v[88:91], v[112:115]
s_waitcnt lgkmcnt(0)
v_and_b32 v104, v100, v148
v_and_b32 v105, v100, v149
v_and_b32 v106, v100, v150
v_and_b32 v107, v100, v151
s_nop 1
v_mfma_f32_16x16x32_bf16 v[112:115], v[104:107], v[92:95], v[112:115]
v_add_u32 v101, v101, v12
s_nop 6
ds_write_b128 v10, v[112:115]
s_waitcnt lgkmcnt(0)
s_barrier
ds_read_b128 v[112:115], v11
s_waitcnt lgkmcnt(0)
v_add_f32_dpp v112, v112, v112 quad_perm:[1,0,3,2] row_mask:0xf bank_mask:0xf
v_add_f32_dpp v113, v113, v113 quad_perm:[1,0,3,2] row_mask:0xf bank_mask:0xf
v_add_f32_dpp v114, v114, v114 quad_perm:[1,0,3,2] row_mask:0xf bank_mask:0xf
v_add_f32_dpp v115, v115, v115 quad_perm:[1,0,3,2] row_mask:0xf bank_mask:0xf
v_add_f32_dpp v112, v112, v112 quad_perm:[2,3,0,1] row_mask:0xf bank_mask:0xf
v_add_f32_dpp v113, v113, v113 quad_perm:[2,3,0,1] row_mask:0xf bank_mask:0xf
v_add_f32_dpp v114, v114, v114 quad_perm:[2,3,0,1] row_mask:0xf bank_mask:0xf
v_add_f32_dpp v115, v115, v115 quad_perm:[2,3,0,1] row_mask:0xf bank_mask:0xf
v_add_f32_dpp v112, v112, v112 row_half_mirror row_mask:0xf bank_mask:0xf
v_add_f32_dpp v113, v113, v113 row_half_mirror row_mask:0xf bank_mask:0xf
v_add_f32_dpp v114, v114, v114 row_half_mirror row_mask:0xf bank_mask:0xf
v_add_f32_dpp v115, v115, v115 row_half_mirror row_mask:0xf bank_mask:0xf
v_and_or_b32 v112, v112, v5, s8
v_and_or_b32 v113, v113, v5, s9
v_and_or_b32 v114, v114, v5, s8
v_and_or_b32 v115, v115, v5, s9
s_mov_b32 exec_lo, 0x01010101
s_mov_b32 exec_hi, 0x01010101
buffer_store_dwordx4 v[112:115], v101, s[72:75], 0 offen sc1
s_mov_b64 exec, -1
s_cmp_eq_u32 s38, 0
s_cbranch_scc0 L_A_noc1
s_cmp_eq_u32 s43, 0
s_cbranch_scc1 L_A_noc1
s_barrier
s_waitcnt vmcnt(7)
buffer_load_dwordx4 v[40:43], v1, s[16:19], s26 offen offset:0 nt
s_waitcnt vmcnt(7)
buffer_load_dwordx4 v[44:47], v1, s[16:19], s26 offen offset:128 nt
s_waitcnt vmcnt(7)
buffer_load_dwordx4 v[48:51], v1, s[16:19], s26 offen offset:256 nt
s_waitcnt vmcnt(7)
buffer_load_dwordx4 v[52:55], v1, s[16:19], s27 offen offset:0 nt
s_waitcnt vmcnt(7)
buffer_load_dwordx4 v[56:59], v1, s[16:19], s27 offen offset:128 nt
s_waitcnt vmcnt(7)
buffer_load_dwordx4 v[60:63], v1, s[16:19], s27 offen offset:256 nt
L_A_noc1:
s_add_u32 s38, s38, 1
s_add_u32 s40, s40, 40960
s_add_u32 s41, s41, s43
s_add_u32 s39, s39, 4
s_cmp_lt_u32 s38, s42
s_cbranch_scc1 L_A_step
s_cmp_eq_u32 s43, 0
s_cbranch_scc0 L_A_lK4
s_cmp_eq_u32 s58, 4
s_cbranch_scc1 L_A_lK3
s_branch L_A_lK4
L_A_lK1:
s_waitcnt vmcnt(7)
buffer_load_dwordx4 v[28:31], v1, s[16:19], s25 offen offset:0 nt
s_waitcnt vmcnt(7)
buffer_load_dwordx4 v[32:35], v1, s[16:19], s25 offen offset:128 nt
s_waitcnt vmcnt(7)
buffer_load_dwordx4 v[36:39], v1, s[16:19], s25 offen offset:256 nt
L_A_lK2:
s_waitcnt vmcnt(7)
buffer_load_dwordx4 v[40:43], v1, s[16:19], s26 offen offset:0 nt
s_waitcnt vmcnt(7)
buffer_load_dwordx4 v[44:47], v1, s[16:19], s26 offen offset:128 nt
s_waitcnt vmcnt(7)
buffer_load_dwordx4 v[48:51], v1, s[16:19], s26 offen offset:256 nt
L_A_lK3:
s_waitcnt vmcnt(7)
buffer_load_dwordx4 v[52:55], v1, s[16:19], s27 offen offset:0 nt
s_waitcnt vmcnt(7)
buffer_load_dwordx4 v[56:59], v1, s[16:19], s27 offen offset:128 nt
s_waitcnt vmcnt(7)
buffer_load_dwordx4 v[60:63], v1, s[16:19], s27 offen offset:256 nt
L_A_lK4:
s_waitcnt vmcnt(7)
buffer_load_dwordx4 v[64:67], v1, s[16:19], s28 offen offset:0 nt
s_waitcnt vmcnt(7)
buffer_load_dwordx4 v[68:71], v1, s[16:19], s28 offen offset:128 nt
s_waitcnt vmcnt(7)
buffer_load_dwordx4 v[72:75], v1, s[16:19], s28 offen offset:256 nt
L_A_lK5:
v_and_b32 v6, 7, v0
v_lshlrev_b32 v6, 4, v6
v_add_u32 v6, 122880, v6
v_mov_b32 v159, 123480
s_cmp_eq_u32 s58, 3
s_cbranch_scc1 L_A_lV2
s_waitcnt vmcnt(7)
buffer_load_dwordx4 v[88:91], v1, s[20:23], s25 offen offset:0 nt
s_waitcnt vmcnt(7)
buffer_load_dwordx4 v[92:95], v1, s[20:23], s25 offen offset:128 nt
s_waitcnt vmcnt(7)
buffer_load_dwordx4 v[96:99], v1, s[20:23], s25 offen offset:256 nt
L_A_lV2:
s_waitcnt vmcnt(7)
buffer_load_dwordx4 v[100:103], v1, s[20:23], s26 offen offset:0 nt
s_waitcnt vmcnt(7)
buffer_load_dwordx4 v[104:107], v1, s[20:23], s26 offen offset:128 nt
s_waitcnt vmcnt(7)
buffer_load_dwordx4 v[108:111], v1, s[20:23], s26 offen offset:256 nt
ds_read_b32 v7, v159
s_waitcnt lgkmcnt(0)
v_readfirstlane_b32 s60, v7
s_nop 1
s_cmp_eq_u32 s60, 1
s_cbranch_scc0 L_qL
ds_read_b128 v[8:11], v6
ds_read_b128 v[12:15], v6 offset:128
ds_read_b128 v[160:163], v6 offset:256
s_waitcnt lgkmcnt(0)
L_qL:
buffer_load_dwordx4 v[112:115], v1, s[20:23], s27 offen offset:0 nt
buffer_load_dwordx4 v[116:119], v1, s[20:23], s27 offen offset:128 nt
buffer_load_dwordx4 v[120:123], v1, s[20:23], s27 offen offset:256 nt
buffer_load_dwordx4 v[124:127], v1, s[20:23], s28 offen offset:0 nt
buffer_load_dwordx4 v[128:131], v1, s[20:23], s28 offen offset:128 nt
buffer_load_dwordx4 v[132:135], v1, s[20:23], s28 offen offset:256 nt
L_A_issued:
v_mov_b32 v152, 0xff800000
v_mov_b32 v153, 0xff800000
v_mov_b32 v154, 0xff800000
v_mov_b32 v155, 0xff800000
v_mov_b32 v156, 0xff800000
v_mov_b32 v136, 0
v_mov_b32 v137, 0
v_mov_b32 v138, 0
v_mov_b32 v139, 0
v_mov_b32 v140, 0
v_mov_b32 v141, 0
v_mov_b32 v142, 0
v_mov_b32 v143, 0
v_mov_b32 v144, 0
v_mov_b32 v145, 0
v_mov_b32 v146, 0
v_mov_b32 v147, 0
s_cmp_eq_u32 s60, 1
s_cbranch_scc1 L_qok
L_qspin:
ds_read_b32 v7, v159
s_waitcnt lgkmcnt(0)
v_readfirstlane_b32 s60, v7
s_nop 1
s_cmp_eq_u32 s60, 1
s_cbranch_scc1 L_qrd
s_add_u32 s95, s95, 1
s_cmp_gt_u32 s95, 0x400000
s_cbranch_scc1 L_qrd
s_sleep 1
s_branch L_qspin
L_qrd:
ds_read_b128 v[8:11], v6
ds_read_b128 v[12:15], v6 offset:128
ds_read_b128 v[160:163], v6 offset:256
L_qok:
v_and_b32 v2, 7, v0
v_lshlrev_b32 v159, 2, v2
v_mul_u32_u24 v3, 1568, v2
v_lshlrev_b32 v2, 5, v2
v_bfe_u32 v4, v0, 4, 1
v_lshlrev_b32 v4, 4, v4
v_add_u32 v2, v2, v4
v_lshrrev_b32 v4, 5, v0
v_mul_u32_u24 v4, 768, v4
v_add_u32 v2, v2, v4
s_mul_i32 s29, s4, 1568
s_add_u32 s29, s29, 141824
v_add_u32 v2, s29, v2
s_lshl_b32 s29, s4, 3
v_lshrrev_b32 v4, 3, v0
v_add_u32 v4, s29, v4
v_lshlrev_b32 v4, 4, v4
v_add_u32 v3, v3, v4
v_add_u32 v3, 141824, v3
v_add_u32 v4, s59, v4
s_lshl_b32 s29, s4, 2
s_add_u32 s29, s29, 123392
v_mov_b32 v7, s29
v_add_u32 v159, 123392, v159
s_mov_b32 s29, 0x3d93cd3a
s_mov_b32 s30, 1069066811
s_cmp_eq_u32 s58, 5
s_cbranch_scc1 L_Qw5
s_cmp_eq_u32 s58, 4
s_cbranch_scc1 L_Qw4
s_cmp_eq_u32 s58, 3
s_cbranch_scc1 L_Qw3
s_waitcnt vmcnt(6) lgkmcnt(0)
s_branch L_Q3
L_Qw3:
s_waitcnt vmcnt(9) lgkmcnt(0)
s_branch L_Q2
L_Qw4:
s_waitcnt vmcnt(12) lgkmcnt(0)
s_branch L_Q1
L_Qw5:
s_waitcnt vmcnt(15) lgkmcnt(0)
v_dot2_f32_bf16 v152, v16, v8, 0
v_dot2_f32_bf16 v157, v20, v12, 0
v_dot2_f32_bf16 v158, v24, v160, 0
s_nop 0
v_dot2c_f32_bf16 v152, v17, v9
v_dot2c_f32_bf16 v157, v21, v13
v_dot2c_f32_bf16 v158, v25, v161
v_dot2c_f32_bf16 v152, v18, v10
v_dot2c_f32_bf16 v157, v22, v14
v_dot2c_f32_bf16 v158, v26, v162
v_dot2c_f32_bf16 v152, v19, v11
v_dot2c_f32_bf16 v157, v23, v15
v_dot2c_f32_bf16 v158, v27, v163
s_nop 2
v_add_f32 v157, v157, v158
v_add_f32 v152, v152, v157
L_Q1:
v_dot2_f32_bf16 v153, v28, v8, 0
v_dot2_f32_bf16 v157, v32, v12, 0
v_dot2_f32_bf16 v158, v36, v160, 0
s_nop 0
v_dot2c_f32_bf16 v153, v29, v9
v_dot2c_f32_bf16 v157, v33, v13
v_dot2c_f32_bf16 v158, v37, v161
v_dot2c_f32_bf16 v153, v30, v10
v_dot2c_f32_bf16 v157, v34, v14
v_dot2c_f32_bf16 v158, v38, v162
v_dot2c_f32_bf16 v153, v31, v11
v_dot2c_f32_bf16 v157, v35, v15
v_dot2c_f32_bf16 v158, v39, v163
s_nop 2
v_add_f32 v157, v157, v158
v_add_f32 v153, v153, v157
L_Q2:
v_dot2_f32_bf16 v154, v40, v8, 0
v_dot2_f32_bf16 v157, v44, v12, 0
v_dot2_f32_bf16 v158, v48, v160, 0
s_nop 0
v_dot2c_f32_bf16 v154, v41, v9
v_dot2c_f32_bf16 v157, v45, v13
v_dot2c_f32_bf16 v158, v49, v161
v_dot2c_f32_bf16 v154, v42, v10
v_dot2c_f32_bf16 v157, v46, v14
v_dot2c_f32_bf16 v158, v50, v162
v_dot2c_f32_bf16 v154, v43, v11
v_dot2c_f32_bf16 v157, v47, v15
v_dot2c_f32_bf16 v158, v51, v163
s_nop 2
v_add_f32 v157, v157, v158
v_add_f32 v154, v154, v157
L_Q3:
v_dot2_f32_bf16 v155, v52, v8, 0
v_dot2_f32_bf16 v157, v56, v12, 0
v_dot2_f32_bf16 v158, v60, v160, 0
s_nop 0
v_dot2c_f32_bf16 v155, v53, v9
v_dot2c_f32_bf16 v157, v57, v13
v_dot2c_f32_bf16 v158, v61, v161
v_dot2c_f32_bf16 v155, v54, v10
v_dot2c_f32_bf16 v157, v58, v14
v_dot2c_f32_bf16 v158, v62, v162
v_dot2c_f32_bf16 v155, v55, v11
v_dot2c_f32_bf16 v157, v59, v15
v_dot2c_f32_bf16 v158, v63, v163
s_nop 2
v_add_f32 v157, v157, v158
v_add_f32 v155, v155, v157
L_Q4:
v_dot2_f32_bf16 v156, v64, v8, 0
v_dot2_f32_bf16 v157, v68, v12, 0
v_dot2_f32_bf16 v158, v72, v160, 0
s_nop 0
v_dot2c_f32_bf16 v156, v65, v9
v_dot2c_f32_bf16 v157, v69, v13
v_dot2c_f32_bf16 v158, v73, v161
v_dot2c_f32_bf16 v156, v66, v10
v_dot2c_f32_bf16 v157, v70, v14
v_dot2c_f32_bf16 v158, v74, v162
v_dot2c_f32_bf16 v156, v67, v11
v_dot2c_f32_bf16 v157, v71, v15
v_dot2c_f32_bf16 v158, v75, v163
s_nop 2
v_add_f32 v157, v157, v158
v_add_f32 v156, v156, v157
v_add_f32_dpp v152, v152, v152 quad_perm:[1,0,3,2] row_mask:0xf bank_mask:0xf
v_add_f32_dpp v153, v153, v153 quad_perm:[1,0,3,2] row_mask:0xf bank_mask:0xf
v_add_f32_dpp v154, v154, v154 quad_perm:[1,0,3,2] row_mask:0xf bank_mask:0xf
v_add_f32_dpp v155, v155, v155 quad_perm:[1,0,3,2] row_mask:0xf bank_mask:0xf
v_add_f32_dpp v156, v156, v156 quad_perm:[1,0,3,2] row_mask:0xf bank_mask:0xf
v_add_f32_dpp v152, v152, v152 quad_perm:[2,3,0,1] row_mask:0xf bank_mask:0xf
v_add_f32_dpp v153, v153, v153 quad_perm:[2,3,0,1] row_mask:0xf bank_mask:0xf
v_add_f32_dpp v154, v154, v154 quad_perm:[2,3,0,1] row_mask:0xf bank_mask:0xf
v_add_f32_dpp v155, v155, v155 quad_perm:[2,3,0,1] row_mask:0xf bank_mask:0xf
v_add_f32_dpp v156, v156, v156 quad_perm:[2,3,0,1] row_mask:0xf bank_mask:0xf
v_add_f32_dpp v152, v152, v152 row_half_mirror row_mask:0xf bank_mask:0xf
v_add_f32_dpp v153, v153, v153 row_half_mirror row_mask:0xf bank_mask:0xf
v_add_f32_dpp v154, v154, v154 row_half_mirror row_mask:0xf bank_mask:0xf
v_add_f32_dpp v155, v155, v155 row_half_mirror row_mask:0xf bank_mask:0xf
v_add_f32_dpp v156, v156, v156 row_half_mirror row_mask:0xf bank_mask:0xf
v_cvt_pk_bf16_f32 v152, v152, v152
v_cvt_pk_bf16_f32 v153, v153, v153
v_cvt_pk_bf16_f32 v154, v154, v154
v_cvt_pk_bf16_f32 v155, v155, v155
v_cvt_pk_bf16_f32 v156, v156, v156
v_and_b32 v152, 0xffff0000, v152
v_and_b32 v153, 0xffff0000, v153
v_and_b32 v154, 0xffff0000, v154
v_and_b32 v155, 0xffff0000, v155
v_and_b32 v156, 0xffff0000, v156
v_mul_f32 v152, s29, v152
v_mul_f32 v153, s29, v153
v_mul_f32 v154, s29, v154
v_mul_f32 v155, s29, v155
v_mul_f32 v156, s29, v156
v_cvt_pk_bf16_f32 v152, v152, v152
v_cvt_pk_bf16_f32 v153, v153, v153
v_cvt_pk_bf16_f32 v154, v154, v154
v_cvt_pk_bf16_f32 v155, v155, v155
v_cvt_pk_bf16_f32 v156, v156, v156
v_and_b32 v152, 0xffff0000, v152
v_and_b32 v153, 0xffff0000, v153
v_and_b32 v154, 0xffff0000, v154
v_and_b32 v155, 0xffff0000, v155
v_and_b32 v156, 0xffff0000, v156
v_max3_f32 v6, v152, v153, v154
v_max3_f32 v6, v6, v155, v156
s_nop 1
v_max_f32_dpp v6, v6, v6 row_ror:8 row_mask:0xf bank_mask:0xf
v_mov_b32 v8, v6
s_nop 1
v_permlane16_swap_b32 v6, v8
v_max_f32 v6, v6, v8
v_mov_b32 v8, v6
s_nop 1
v_permlane32_swap_b32 v6, v8
v_max_f32 v6, v6, v8
v_sub_f32 v152, v152, v6
v_sub_f32 v153, v153, v6
v_sub_f32 v154, v154, v6
v_sub_f32 v155, v155, v6
v_sub_f32 v156, v156, v6
v_mul_f32 v152, s30, v152
v_mul_f32 v153, s30, v153
v_mul_f32 v154, s30, v154
v_mul_f32 v155, s30, v155
v_mul_f32 v156, s30, v156
v_exp_f32 v152, v152
v_exp_f32 v153, v153
v_exp_f32 v154, v154
v_exp_f32 v155, v155
v_exp_f32 v156, v156
ds_write_b32 v7, v6
v_add_f32 v8, v152, v153
v_add_f32 v9, v154, v155
v_add_f32 v8, v8, v156
v_cvt_pk_bf16_f32 v152, v152, v152
v_cvt_pk_bf16_f32 v153, v153, v153
v_cvt_pk_bf16_f32 v154, v154, v154
v_cvt_pk_bf16_f32 v155, v155, v155
v_cvt_pk_bf16_f32 v156, v156, v156
v_add_f32 v8, v8, v9
s_cmp_eq_u32 s58, 4
s_cbranch_scc1 L_P1
s_cmp_eq_u32 s58, 3
s_cbranch_scc1 L_P2
s_cmp_eq_u32 s58, 2
s_cbranch_scc1 L_P3
v_and_b32 v16, v152, v148
v_and_b32 v17, v152, v149
v_and_b32 v18, v152, v150
v_and_b32 v19, v152, v151
s_waitcnt vmcnt(14)
s_nop 0
v_mfma_f32_16x16x32_bf16 v[136:139], v[16:19], v[76:79], v[136:139]
s_waitcnt vmcnt(13)
v_mfma_f32_16x16x32_bf16 v[140:143], v[16:19], v[80:83], v[140:143]
s_waitcnt vmcnt(12)
v_mfma_f32_16x16x32_bf16 v[144:147], v[16:19], v[84:87], v[144:147]
L_P1:
v_and_b32 v20, v153, v148
v_and_b32 v21, v153, v149
v_and_b32 v22, v153, v150
v_and_b32 v23, v153, v151
s_waitcnt vmcnt(11)
s_nop 0
v_mfma_f32_16x16x32_bf16 v[136:139], v[20:23], v[88:91], v[136:139]
s_waitcnt vmcnt(10)
v_mfma_f32_16x16x32_bf16 v[140:143], v[20:23], v[92:95], v[140:143]
s_waitcnt vmcnt(9)
v_mfma_f32_16x16x32_bf16 v[144:147], v[20:23], v[96:99], v[144:147]
L_P2:
v_and_b32 v16, v154, v148
v_and_b32 v17, v154, v149
v_and_b32 v18, v154, v150
v_and_b32 v19, v154, v151
s_waitcnt vmcnt(8)
s_nop 0
v_mfma_f32_16x16x32_bf16 v[136:139], v[16:19], v[100:103], v[136:139]
s_waitcnt vmcnt(7)
v_mfma_f32_16x16x32_bf16 v[140:143], v[16:19], v[104:107], v[140:143]
s_waitcnt vmcnt(6)
v_mfma_f32_16x16x32_bf16 v[144:147], v[16:19], v[108:111], v[144:147]
L_P3:
v_and_b32 v20, v155, v148
v_and_b32 v21, v155, v149
v_and_b32 v22, v155, v150
v_and_b32 v23, v155, v151
s_waitcnt vmcnt(5)
s_nop 0
v_mfma_f32_16x16x32_bf16 v[136:139], v[20:23], v[112:115], v[136:139]
s_waitcnt vmcnt(4)
v_mfma_f32_16x16x32_bf16 v[140:143], v[20:23], v[116:119], v[140:143]
s_waitcnt vmcnt(3)
v_mfma_f32_16x16x32_bf16 v[144:147], v[20:23], v[120:123], v[144:147]
v_add_f32_dpp v8, v8, v8 row_ror:8 row_mask:0xf bank_mask:0xf
v_mov_b32 v9, v8
s_nop 1
v_permlane16_swap_b32 v8, v9
v_add_f32 v8, v8, v9
v_mov_b32 v9, v8
s_nop 1
v_permlane32_swap_b32 v8, v9
v_add_f32 v8, v8, v9
ds_write_b32 v7, v8 offset:32
v_and_b32 v16, v156, v148
v_and_b32 v17, v156, v149
v_and_b32 v18, v156, v150
v_and_b32 v19, v156, v151
s_waitcnt vmcnt(2)
s_nop 0
v_mfma_f32_16x16x32_bf16 v[136:139], v[16:19], v[124:127], v[136:139]
s_waitcnt vmcnt(1)
v_mfma_f32_16x16x32_bf16 v[140:143], v[16:19], v[128:131], v[140:143]
s_waitcnt vmcnt(0)
v_mfma_f32_16x16x32_bf16 v[144:147], v[16:19], v[132:135], v[144:147]
s_mov_b32 exec_lo, 0x00ff00ff
s_mov_b32 exec_hi, 0xff00ff00
s_nop 1
ds_write_b128 v2, v[136:139]
s_nop 0
ds_write_b128 v2, v[140:143] offset:256
s_nop 0
ds_write_b128 v2, v[144:147] offset:512
s_mov_b64 exec, -1
v_mov_b32 v6, 123392
s_waitcnt lgkmcnt(0)
s_barrier
ds_read_b128 v[16:19], v6
ds_read_b128 v[20:23], v6 offset:16
s_cmp_ge_u32 s4, 6
s_cbranch_scc1 L_A_ml
ds_read_b32 v24, v159
ds_read_b128 v[8:11], v3
ds_read_b128 v[12:15], v3 offset:768
s_waitcnt lgkmcnt(3)
v_max3_f32 v16, v16, v17, v18
v_max3_f32 v20, v20, v21, v22
v_max3_f32 v16, v16, v19, v23
v_max_f32 v16, v16, v20
s_waitcnt lgkmcnt(2)
v_sub_f32 v24, v24, v16
v_mul_f32 v24, s30, v24
v_exp_f32 v24, v24
s_waitcnt lgkmcnt(0)
v_add_f32 v8, v8, v12
v_add_f32 v9, v9, v13
v_add_f32 v10, v10, v14
v_add_f32 v11, v11, v15
v_mul_f32 v8, v8, v24
v_mul_f32 v9, v9, v24
v_mul_f32 v10, v10, v24
v_mul_f32 v11, v11, v24
v_add_f32_dpp v8, v8, v8 quad_perm:[1,0,3,2] row_mask:0xf bank_mask:0xf
v_add_f32_dpp v9, v9, v9 quad_perm:[1,0,3,2] row_mask:0xf bank_mask:0xf
v_add_f32_dpp v10, v10, v10 quad_perm:[1,0,3,2] row_mask:0xf bank_mask:0xf
v_add_f32_dpp v11, v11, v11 quad_perm:[1,0,3,2] row_mask:0xf bank_mask:0xf
v_add_f32_dpp v8, v8, v8 quad_perm:[2,3,0,1] row_mask:0xf bank_mask:0xf
v_add_f32_dpp v9, v9, v9 quad_perm:[2,3,0,1] row_mask:0xf bank_mask:0xf
v_add_f32_dpp v10, v10, v10 quad_perm:[2,3,0,1] row_mask:0xf bank_mask:0xf
v_add_f32_dpp v11, v11, v11 quad_perm:[2,3,0,1] row_mask:0xf bank_mask:0xf
v_add_f32_dpp v8, v8, v8 row_half_mirror row_mask:0xf bank_mask:0xf
v_add_f32_dpp v9, v9, v9 row_half_mirror row_mask:0xf bank_mask:0xf
v_add_f32_dpp v10, v10, v10 row_half_mirror row_mask:0xf bank_mask:0xf
v_add_f32_dpp v11, v11, v11 row_half_mirror row_mask:0xf bank_mask:0xf
v_and_or_b32 v8, v8, v5, s8
v_and_or_b32 v9, v9, v5, s9
v_and_or_b32 v10, v10, v5, s8
v_and_or_b32 v11, v11, v5, s9
s_mov_b32 exec_lo, 0x01010101
s_mov_b32 exec_hi, 0x01010101
v_add_u32 v14, 589824, v4
buffer_store_dwordx4 v[8:11], v14, s[72:75], 0 offen
buffer_store_dwordx4 v[8:11], v4, s[72:75], 0 offen sc1
s_mov_b64 exec, -1
s_branch L_A_tail
L_A_ml:
s_cmp_eq_u32 s4, 6
s_cbranch_scc0 L_A_tail
ds_read_b128 v[8:11], v6 offset:32
ds_read_b128 v[12:15], v6 offset:48
s_add_u32 s29, s59, 768
v_mov_b32 v4, s29
s_waitcnt lgkmcnt(2)
v_max3_f32 v24, v16, v17, v18
v_max3_f32 v25, v20, v21, v22
v_max3_f32 v24, v24, v19, v23
v_max_f32 v24, v24, v25
v_sub_f32 v16, v16, v24
v_sub_f32 v17, v17, v24
v_sub_f32 v18, v18, v24
v_sub_f32 v19, v19, v24
v_sub_f32 v20, v20, v24
v_sub_f32 v21, v21, v24
v_sub_f32 v22, v22, v24
v_sub_f32 v23, v23, v24
v_mul_f32 v16, s30, v16
v_mul_f32 v17, s30, v17
v_mul_f32 v18, s30, v18
v_mul_f32 v19, s30, v19
v_mul_f32 v20, s30, v20
v_mul_f32 v21, s30, v21
v_mul_f32 v22, s30, v22
v_mul_f32 v23, s30, v23
v_exp_f32 v16, v16
v_exp_f32 v17, v17
v_exp_f32 v18, v18
v_exp_f32 v19, v19
v_exp_f32 v20, v20
v_exp_f32 v21, v21
v_exp_f32 v22, v22
v_exp_f32 v23, v23
s_waitcnt lgkmcnt(0)
v_mul_f32 v9, v9, v17
v_fmac_f32 v9, v8, v16
v_fmac_f32 v9, v10, v18
v_fmac_f32 v9, v11, v19
v_fmac_f32 v9, v12, v20
v_fmac_f32 v9, v13, v21
v_fmac_f32 v9, v14, v22
v_fmac_f32 v9, v15, v23
v_mov_b32 v8, v24
v_mov_b32 v10, v24
v_mov_b32 v11, v9
v_and_or_b32 v8, v8, v5, s8
v_and_or_b32 v9, v9, v5, s9
v_and_or_b32 v10, v10, v5, s8
v_and_or_b32 v11, v11, v5, s9
s_mov_b64 exec, 1
v_add_u32 v14, 589824, v4
buffer_store_dwordx4 v[8:11], v14, s[72:75], 0 offen
buffer_store_dwordx4 v[8:11], v4, s[72:75], 0 offen sc1
s_mov_b64 exec, -1
L_A_tail:
s_cmp_lt_u32 s6, 10
s_cbranch_scc1 L_WO
s_cmp_lt_u32 s6, 16
s_cbranch_scc1 L_FFN
s_endpgm
L_WO:
s_lshl_b32 s29, s5, 5
s_lshl_b32 s30, s4, 2
s_add_u32 s29, s29, s30
s_lshl_b32 s29, s29, 10
s_add_u32 s29, s29, 917504
v_lshlrev_b32 v160, 4, v0
v_add_u32 v160, s29, v160
v_mov_b32 v161, s29
v_mov_b32 v162, 0
s_lshl_b32 s33, s4, 9
s_cmp_ge_u32 s4, 2
s_cbranch_scc1 L_WO_n0
s_lshr_b32 s29, s6, 1
s_add_u32 s29, s29, 10
s_lshl_b32 s29, s29, 12
s_and_b32 s30, s6, 1
s_lshl_b32 s30, s30, 8
s_add_u32 s29, s29, s30
s_add_u32 s29, s29, s33
s_add_u32 s29, s29, 4096
v_bfe_u32 v162, v0, 2, 4
v_lshlrev_b32 v162, 4, v162
v_add_u32 v162, s29, v162
buffer_load_dwordx4 v[96:99], v162, s[72:75], 0 offen offset:0 sc1
buffer_load_dwordx4 v[100:103], v162, s[72:75], 0 offen offset:1024 sc1
buffer_load_dwordx4 v[104:107], v162, s[72:75], 0 offen offset:2048 sc1
buffer_load_dwordx4 v[108:111], v162, s[72:75], 0 offen offset:3072 sc1
L_WO_n0:
s_mov_b32 exec_lo, -1
s_mov_b32 exec_hi, 0x0000ffff
buffer_load_dwordx4 v[64:67], v160, s[72:75], 0 offen offset:0 sc1
buffer_load_dwordx4 v[68:71], v160, s[72:75], 0 offen offset:1024 sc1
buffer_load_dwordx4 v[72:75], v160, s[72:75], 0 offen offset:2048 sc1
buffer_load_dwordx4 v[76:79], v160, s[72:75], 0 offen offset:3072 sc1
buffer_load_dwordx4 v[80:83], v161, s[72:75], 0 offen offset:768 sc1
buffer_load_dwordx4 v[84:87], v161, s[72:75], 0 offen offset:1792 sc1
buffer_load_dwordx4 v[88:91], v161, s[72:75], 0 offen offset:2816 sc1
buffer_load_dwordx4 v[92:95], v161, s[72:75], 0 offen offset:3840 sc1
s_mov_b64 exec, -1
v_lshrrev_b32 v2, 4, v0
v_bfe_u32 v3, v0, 2, 2
v_lshlrev_b32 v8, 3, v2
v_add_u32 v8, v8, v3
v_lshlrev_b32 v8, 7, v8
v_and_b32 v9, 1, v0
v_lshlrev_b32 v9, 3, v9
v_add_u32 v8, v8, v9
v_and_b32 v3, 2, v3
v_and_b32 v2, 1, v2
v_lshlrev_b32 v2, 2, v2
v_or_b32 v3, v3, v2
v_bfe_u32 v2, v0, 1, 1
s_lshr_b32 s29, s4, 2
s_lshl_b32 s29, s29, 2
v_add_u32 v2, s29, v2
v_xor_b32 v9, v2, v3
v_add_u32 v2, 2, v2
v_xor_b32 v10, v2, v3
v_lshlrev_b32 v9, 4, v9
v_lshlrev_b32 v10, 4, v10
s_and_b32 s29, s4, 3
s_mul_i32 s29, s29, 24576
s_add_u32 s29, s29, 0
v_add3_u32 v9, v9, v8, s29
v_add3_u32 v10, v10, v8, s29
ds_read_b64_tr_b16 v[16:17], v9 offset:0
ds_read_b64_tr_b16 v[18:19], v9 offset:512
ds_read_b64_tr_b16 v[20:21], v10 offset:0
ds_read_b64_tr_b16 v[22:23], v10 offset:512
ds_read_b64_tr_b16 v[24:25], v9 offset:4096
ds_read_b64_tr_b16 v[26:27], v9 offset:4608
ds_read_b64_tr_b16 v[28:29], v10 offset:4096
ds_read_b64_tr_b16 v[30:31], v10 offset:4608
s_waitcnt lgkmcnt(4)
ds_read_b64_tr_b16 v[32:33], v9 offset:8192
ds_read_b64_tr_b16 v[34:35], v9 offset:8704
ds_read_b64_tr_b16 v[36:37], v10 offset:8192
ds_read_b64_tr_b16 v[38:39], v10 offset:8704
ds_read_b64_tr_b16 v[40:41], v9 offset:12288
ds_read_b64_tr_b16 v[42:43], v9 offset:12800
ds_read_b64_tr_b16 v[44:45], v10 offset:12288
ds_read_b64_tr_b16 v[46:47], v10 offset:12800
s_waitcnt lgkmcnt(4)
ds_read_b64_tr_b16 v[48:49], v9 offset:16384
ds_read_b64_tr_b16 v[50:51], v9 offset:16896
ds_read_b64_tr_b16 v[52:53], v10 offset:16384
ds_read_b64_tr_b16 v[54:55], v10 offset:16896
ds_read_b64_tr_b16 v[56:57], v9 offset:20480
ds_read_b64_tr_b16 v[58:59], v9 offset:20992
ds_read_b64_tr_b16 v[60:61], v10 offset:20480
ds_read_b64_tr_b16 v[62:63], v10 offset:20992
s_waitcnt lgkmcnt(4)
v_and_b32 v12, 1, v0
v_mul_u32_u24 v12, 1600, v12
v_lshrrev_b32 v2, 4, v0
v_lshlrev_b32 v2, 4, v2
s_and_b32 s29, s4, 3
s_mul_i32 s30, s29, 384
s_add_u32 s30, s30, 128000
v_add3_u32 v12, v12, v2, s30
v_and_b32 v13, 3, v0
v_lshlrev_b32 v13, 8, v13
s_mul_i32 s30, s29, 1088
s_lshr_b32 s29, s4, 2
s_lshl_b32 s29, s29, 7
s_add_u32 s30, s30, s29
s_add_u32 s30, s30, 141824
v_add3_u32 v13, v13, v2, s30
v_mov_b32 v15, 0
v_mov_b32 v14, 0
s_cmp_ge_u32 s4, 2
s_cbranch_scc1 L_WO_nr
v_bfe_u32 v2, v0, 2, 4
v_lshlrev_b32 v2, 4, v2
s_lshl_b32 s29, s4, 8
v_and_b32 v3, 3, v0
v_mul_u32_u24 v3, 1088, v3
v_add3_u32 v14, v2, v3, s29
v_add_u32 v14, 141824, v14
s_lshr_b32 s29, s6, 1
s_lshl_b32 s29, s29, 10
s_and_b32 s30, s6, 1
s_lshl_b32 s30, s30, 8
s_add_u32 s29, s29, s30
s_add_u32 s29, s29, s33
s_mul_i32 s30, s5, 5120
s_add_u32 s29, s29, s30
s_add_u32 s29, s29, 589824
v_add_u32 v15, s29, v2
L_WO_nr:
s_and_b32 s29, s4, 3
s_mul_i32 s29, s29, 384
s_lshr_b32 s30, s4, 2
s_mul_i32 s30, s30, 1600
s_add_u32 s29, s29, s30
s_add_u32 s29, s29, 128000
v_lshlrev_b32 v11, 3, v0
v_add_u32 v11, s29, v11
s_mov_b32 s28, 1069066811
s_mov_b32 s34, 589824
s_mov_b32 s35, 0
s_waitcnt lgkmcnt(0)
s_mov_b32 exec_lo, -1
s_mov_b32 exec_hi, 0x0000ffff
s_branch L_WO_chk
L_WO_poll:
buffer_load_dwordx4 v[64:67], v160, s[72:75], 0 offen offset:0 sc1
buffer_load_dwordx4 v[68:71], v160, s[72:75], 0 offen offset:1024 sc1
buffer_load_dwordx4 v[72:75], v160, s[72:75], 0 offen offset:2048 sc1
buffer_load_dwordx4 v[76:79], v160, s[72:75], 0 offen offset:3072 sc1
buffer_load_dwordx4 v[80:83], v161, s[72:75], 0 offen offset:768 sc1
buffer_load_dwordx4 v[84:87], v161, s[72:75], 0 offen offset:1792 sc1
buffer_load_dwordx4 v[88:91], v161, s[72:75], 0 offen offset:2816 sc1
buffer_load_dwordx4 v[92:95], v161, s[72:75], 0 offen offset:3840 sc1
L_WO_chk:
s_add_u32 s35, s35, 1
s_and_b32 s36, s35, 7
s_cmp_eq_u32 s36, 7
s_cbranch_scc1 L_WO_sw1
s_cmp_eq_u32 s36, 0
s_cbranch_scc0 L_WO_sw2
v_add_u32 v160, s34, v160
v_add_u32 v161, s34, v161
s_branch L_WO_sw2
L_WO_sw1:
v_subrev_u32 v160, s34, v160
v_subrev_u32 v161, s34, v161
L_WO_sw2:
s_waitcnt vmcnt(0)
v_msad_u8 v7, v64, s8, 0
v_msad_u8 v7, v65, s9, v7
v_msad_u8 v7, v66, s8, v7
v_msad_u8 v7, v67, s9, v7
v_msad_u8 v7, v68, s8, v7
v_msad_u8 v7, v69, s9, v7
v_msad_u8 v7, v70, s8, v7
v_msad_u8 v7, v71, s9, v7
v_msad_u8 v7, v72, s8, v7
v_msad_u8 v7, v73, s9, v7
v_msad_u8 v7, v74, s8, v7
v_msad_u8 v7, v75, s9, v7
v_msad_u8 v7, v76, s8, v7
v_msad_u8 v7, v77, s9, v7
v_msad_u8 v7, v78, s8, v7
v_msad_u8 v7, v79, s9, v7
v_msad_u8 v6, v80, s8, 0
v_msad_u8 v6, v81, s9, v6
v_msad_u8 v6, v82, s8, v6
v_msad_u8 v6, v83, s9, v6
v_msad_u8 v6, v84, s8, v6
v_msad_u8 v6, v85, s9, v6
v_msad_u8 v6, v86, s8, v6
v_msad_u8 v6, v87, s9, v6
v_msad_u8 v6, v88, s8, v6
v_msad_u8 v6, v89, s9, v6
v_msad_u8 v6, v90, s8, v6
v_msad_u8 v6, v91, s9, v6
v_msad_u8 v6, v92, s8, v6
v_msad_u8 v6, v93, s9, v6
v_msad_u8 v6, v94, s8, v6
v_msad_u8 v6, v95, s9, v6
v_or_b32 v7, v7, v6
v_cmp_ne_u32 vcc, 0, v7
s_nop 1
s_cbranch_vccz L_WO_poll_ok
s_add_u32 s95, s95, 1
s_cmp_gt_u32 s95, 0x10000
s_cbranch_scc1 L_WO_poll_ok
s_branch L_WO_poll
L_WO_poll_ok:
v_and_b32 v80, v5, v80
v_and_b32 v84, v5, v84
v_and_b32 v88, v5, v88
v_and_b32 v92, v5, v92
v_max_f32 v6, v80, v84
v_max3_f32 v6, v6, v88, v92
v_sub_f32 v80, v80, v6
v_sub_f32 v84, v84, v6
v_sub_f32 v88, v88, v6
v_sub_f32 v92, v92, v6
v_mul_f32 v80, s28, v80
v_mul_f32 v84, s28, v84
v_mul_f32 v88, s28, v88
v_mul_f32 v92, s28, v92
v_exp_f32 v80, v80
v_exp_f32 v84, v84
v_exp_f32 v88, v88
v_exp_f32 v92, v92
v_mul_f32 v7, v80, v81
v_fmac_f32 v7, v84, v85
v_fmac_f32 v7, v88, v89
v_fmac_f32 v7, v92, v93
v_rcp_f32 v7, v7
v_mul_f32 v128, v80, v64
v_mul_f32 v129, v80, v65
v_mul_f32 v130, v80, v66
v_mul_f32 v131, v80, v67
v_fmac_f32 v128, v84, v68
v_fmac_f32 v129, v84, v69
v_fmac_f32 v130, v84, v70
v_fmac_f32 v131, v84, v71
v_fmac_f32 v128, v88, v72
v_fmac_f32 v129, v88, v73
v_fmac_f32 v130, v88, v74
v_fmac_f32 v131, v88, v75
v_fmac_f32 v128, v92, v76
v_fmac_f32 v129, v92, v77
v_fmac_f32 v130, v92, v78
v_fmac_f32 v131, v92, v79
v_mul_f32 v128, v128, v7
v_mul_f32 v129, v129, v7
v_mul_f32 v130, v130, v7
v_mul_f32 v131, v131, v7
v_cvt_pk_bf16_f32 v128, v128, v129
v_cvt_pk_bf16_f32 v129, v130, v131
ds_write_b64 v11, v[128:129]
s_mov_b64 exec, -1
s_waitcnt lgkmcnt(0)
s_barrier
ds_read_b128 v[64:67], v12 offset:0
ds_read_b128 v[68:71], v12 offset:64
ds_read_b128 v[72:75], v12 offset:128
ds_read_b128 v[76:79], v12 offset:192
ds_read_b128 v[80:83], v12 offset:256
ds_read_b128 v[84:87], v12 offset:320
s_cmp_ge_u32 s4, 2
s_cbranch_scc1 L_WO_gad
v_msad_u8 v7, v96, s8, 0
v_msad_u8 v7, v97, s9, v7
v_msad_u8 v7, v98, s8, v7
v_msad_u8 v7, v99, s9, v7
v_msad_u8 v7, v100, s8, v7
v_msad_u8 v7, v101, s9, v7
v_msad_u8 v7, v102, s8, v7
v_msad_u8 v7, v103, s9, v7
v_msad_u8 v7, v104, s8, v7
v_msad_u8 v7, v105, s9, v7
v_msad_u8 v7, v106, s8, v7
v_msad_u8 v7, v107, s9, v7
v_msad_u8 v7, v108, s8, v7
v_msad_u8 v7, v109, s9, v7
v_msad_u8 v7, v110, s8, v7
v_msad_u8 v7, v111, s9, v7
v_cmp_ne_u32 vcc, 0, v7
s_nop 1
s_cbranch_vccz L_WO_gas
L_WO_ga:
buffer_load_dwordx4 v[96:99], v162, s[72:75], 0 offen offset:0 sc1
buffer_load_dwordx4 v[100:103], v162, s[72:75], 0 offen offset:1024 sc1
buffer_load_dwordx4 v[104:107], v162, s[72:75], 0 offen offset:2048 sc1
buffer_load_dwordx4 v[108:111], v162, s[72:75], 0 offen offset:3072 sc1
s_waitcnt vmcnt(0)
v_msad_u8 v7, v96, s8, 0
v_msad_u8 v7, v97, s9, v7
v_msad_u8 v7, v98, s8, v7
v_msad_u8 v7, v99, s9, v7
v_msad_u8 v7, v100, s8, v7
v_msad_u8 v7, v101, s9, v7
v_msad_u8 v7, v102, s8, v7
v_msad_u8 v7, v103, s9, v7
v_msad_u8 v7, v104, s8, v7
v_msad_u8 v7, v105, s9, v7
v_msad_u8 v7, v106, s8, v7
v_msad_u8 v7, v107, s9, v7
v_msad_u8 v7, v108, s8, v7
v_msad_u8 v7, v109, s9, v7
v_msad_u8 v7, v110, s8, v7
v_msad_u8 v7, v111, s9, v7
v_cmp_ne_u32 vcc, 0, v7
s_nop 1
s_cbranch_vccz L_WO_ga_ok
s_add_u32 s95, s95, 1
s_cmp_gt_u32 s95, 0x10000
s_cbranch_scc1 L_WO_ga_ok
s_sleep 1
s_branch L_WO_ga
L_WO_ga_ok:
L_WO_gas:
v_pk_add_f32 v[96:97], v[96:97], v[100:101]
v_pk_add_f32 v[98:99], v[98:99], v[102:103]
v_pk_add_f32 v[104:105], v[104:105], v[108:109]
v_pk_add_f32 v[106:107], v[106:107], v[110:111]
v_pk_add_f32 v[96:97], v[96:97], v[104:105]
v_pk_add_f32 v[98:99], v[98:99], v[106:107]
v_cvt_pk_bf16_f32 v96, v96, v96
v_cvt_pk_bf16_f32 v97, v97, v97
v_cvt_pk_bf16_f32 v98, v98, v98
v_cvt_pk_bf16_f32 v99, v99, v99
v_and_b32 v96, 0xffff0000, v96
v_and_b32 v97, 0xffff0000, v97
v_and_b32 v98, 0xffff0000, v98
v_and_b32 v99, 0xffff0000, v99
L_WO_gad:
s_waitcnt lgkmcnt(5)
v_mfma_f32_16x16x32_bf16 v[112:115], v[16:19], v[64:67], 0
v_mfma_f32_16x16x32_bf16 v[116:119], v[20:23], v[64:67], 0
s_waitcnt lgkmcnt(4)
v_mfma_f32_16x16x32_bf16 v[112:115], v[24:27], v[68:71], v[112:115]
v_mfma_f32_16x16x32_bf16 v[116:119], v[28:31], v[68:71], v[116:119]
s_waitcnt lgkmcnt(3)
v_mfma_f32_16x16x32_bf16 v[112:115], v[32:35], v[72:75], v[112:115]
v_mfma_f32_16x16x32_bf16 v[116:119], v[36:39], v[72:75], v[116:119]
s_waitcnt lgkmcnt(2)
v_mfma_f32_16x16x32_bf16 v[112:115], v[40:43], v[76:79], v[112:115]
v_mfma_f32_16x16x32_bf16 v[116:119], v[44:47], v[76:79], v[116:119]
s_waitcnt lgkmcnt(1)
v_mfma_f32_16x16x32_bf16 v[112:115], v[48:51], v[80:83], v[112:115]
v_mfma_f32_16x16x32_bf16 v[116:119], v[52:55], v[80:83], v[116:119]
s_waitcnt lgkmcnt(0)
v_mfma_f32_16x16x32_bf16 v[112:115], v[56:59], v[84:87], v[112:115]
v_mfma_f32_16x16x32_bf16 v[116:119], v[60:63], v[84:87], v[116:119]
s_mov_b32 exec_lo, 0x000f000f
s_mov_b32 exec_hi, 0x000f000f
s_nop 4
ds_write_b128 v13, v[112:115]
ds_write_b128 v13, v[116:119] offset:64
s_mov_b64 exec, -1
s_waitcnt lgkmcnt(0)
s_barrier
s_cmp_ge_u32 s4, 2
s_cbranch_scc1 L_exit
ds_read_b128 v[8:11], v14
s_waitcnt lgkmcnt(0)
v_add_f32_dpp v8, v8, v8 quad_perm:[1,0,3,2] row_mask:0xf bank_mask:0xf
v_add_f32_dpp v9, v9, v9 quad_perm:[1,0,3,2] row_mask:0xf bank_mask:0xf
v_add_f32_dpp v10, v10, v10 quad_perm:[1,0,3,2] row_mask:0xf bank_mask:0xf
v_add_f32_dpp v11, v11, v11 quad_perm:[1,0,3,2] row_mask:0xf bank_mask:0xf
v_add_f32_dpp v8, v8, v8 quad_perm:[2,3,0,1] row_mask:0xf bank_mask:0xf
v_add_f32_dpp v9, v9, v9 quad_perm:[2,3,0,1] row_mask:0xf bank_mask:0xf
v_add_f32_dpp v10, v10, v10 quad_perm:[2,3,0,1] row_mask:0xf bank_mask:0xf
v_add_f32_dpp v11, v11, v11 quad_perm:[2,3,0,1] row_mask:0xf bank_mask:0xf
v_mul_f32 v8, v8, v96
v_mul_f32 v9, v9, v97
v_mul_f32 v10, v10, v98
v_mul_f32 v11, v11, v99
v_and_or_b32 v8, v8, v5, s8
v_and_or_b32 v9, v9, v5, s9
v_and_or_b32 v10, v10, v5, s8
v_and_or_b32 v11, v11, v5, s9
s_mov_b32 exec_lo, 0x11111111
s_mov_b32 exec_hi, 0x11111111
buffer_store_dwordx4 v[8:11], v15, s[72:75], 0 offen sc1
s_endpgm
L_FFN:
s_sub_u32 s31, s6, 10
s_lshr_b32 s3, s31, 1
s_mov_b32 s30, 4224
s_lshl_b32 s29, s5, 1
s_lshr_b32 s30, s30, s29
s_and_b32 s30, s30, 3
s_add_u32 s3, s3, s30
s_cmp_ge_u32 s3, 3
s_cselect_b32 s30, 3, 0
s_sub_u32 s3, s3, s30
s_lshl_b32 s3, s3, 1
s_and_b32 s31, s31, 1
s_add_u32 s31, s31, s3
s_mul_i32 s3, s5, 6
s_add_u32 s31, s31, s3
v_lshrrev_b32 v2, 4, v0
v_bfe_u32 v3, v0, 2, 2
v_lshlrev_b32 v8, 3, v2
v_add_u32 v8, v8, v3
v_lshlrev_b32 v8, 7, v8
v_and_b32 v9, 1, v0
v_lshlrev_b32 v9, 3, v9
v_add_u32 v8, v8, v9
v_and_b32 v3, 2, v3
v_and_b32 v2, 1, v2
v_lshlrev_b32 v2, 2, v2
v_or_b32 v3, v3, v2
v_bfe_u32 v2, v0, 1, 1
s_lshr_b32 s29, s4, 2
s_lshl_b32 s29, s29, 2
v_add_u32 v2, s29, v2
v_xor_b32 v9, v2, v3
v_add_u32 v2, 2, v2
v_xor_b32 v10, v2, v3
v_lshlrev_b32 v9, 4, v9
v_lshlrev_b32 v10, 4, v10
s_and_b32 s29, s4, 3
s_mul_i32 s29, s29, 20480
s_add_u32 s29, s29, 0
v_add3_u32 v9, v9, v8, s29
v_add3_u32 v10, v10, v8, s29
ds_read_b64_tr_b16 v[16:17], v9 offset:0
ds_read_b64_tr_b16 v[18:19], v9 offset:512
ds_read_b64_tr_b16 v[20:21], v10 offset:0
ds_read_b64_tr_b16 v[22:23], v10 offset:512
ds_read_b64_tr_b16 v[24:25], v9 offset:4096
ds_read_b64_tr_b16 v[26:27], v9 offset:4608
ds_read_b64_tr_b16 v[28:29], v10 offset:4096
ds_read_b64_tr_b16 v[30:31], v10 offset:4608
s_waitcnt lgkmcnt(4)
ds_read_b64_tr_b16 v[32:33], v9 offset:8192
ds_read_b64_tr_b16 v[34:35], v9 offset:8704
ds_read_b64_tr_b16 v[36:37], v10 offset:8192
ds_read_b64_tr_b16 v[38:39], v10 offset:8704
ds_read_b64_tr_b16 v[40:41], v9 offset:12288
ds_read_b64_tr_b16 v[42:43], v9 offset:12800
ds_read_b64_tr_b16 v[44:45], v10 offset:12288
ds_read_b64_tr_b16 v[46:47], v10 offset:12800
s_waitcnt lgkmcnt(4)
ds_read_b64_tr_b16 v[48:49], v9 offset:16384
ds_read_b64_tr_b16 v[50:51], v9 offset:16896
ds_read_b64_tr_b16 v[52:53], v10 offset:16384
ds_read_b64_tr_b16 v[54:55], v10 offset:16896
s_waitcnt lgkmcnt(0)
v_and_b32 v12, 3, v0
v_mul_u32_u24 v12, 1344, v12
v_lshrrev_b32 v2, 4, v0
v_lshlrev_b32 v2, 4, v2
s_and_b32 s29, s4, 3
s_mul_i32 s30, s29, 320
s_add_u32 s30, s30, 128000
v_add3_u32 v12, v12, v2, s30
v_and_b32 v13, 3, v0
v_lshlrev_b32 v13, 8, v13
s_mul_i32 s30, s29, 1088
s_lshr_b32 s29, s4, 2
s_lshl_b32 s29, s29, 7
s_add_u32 s30, s30, s29
s_add_u32 s30, s30, 141824
v_add3_u32 v13, v13, v2, s30
v_add_u32 v14, 2688, v12
v_and_b32 v11, 2, v0
v_mul_u32_u24 v11, 1344, v11
v_sub_u32 v11, v12, v11
v_lshlrev_b32 v2, 4, v0
s_cmp_ge_u32 s4, 5
s_cbranch_scc1 L_FFN_w5
v_lshrrev_b32 v3, 5, v0
v_mul_u32_u24 v12, 1280, v3
v_and_b32 v4, 31, v0
v_lshlrev_b32 v4, 3, v4
v_add_u32 v12, v12, v4
s_lshl_b32 s29, s4, 8
v_add_u32 v12, s29, v12
global_load_dwordx2 v[120:121], v12, s[44:45]
v_mul_u32_u24 v12, 1344, v3
v_add3_u32 v12, v12, v4, s29
v_add_u32 v12, 128000, v12
s_add_u32 s29, s4, 15
s_lshl_b32 s29, s29, 12
s_add_u32 s29, s29, 4096
v_add_u32 v3, s29, v2
v_add_u32 v4, 20480, v3
L_FFN_sc:
buffer_load_dwordx4 v[128:131], v3, s[72:75], 0 offen offset:0 sc1
buffer_load_dwordx4 v[132:135], v3, s[72:75], 0 offen offset:1024 sc1
buffer_load_dwordx4 v[136:139], v3, s[72:75], 0 offen offset:2048 sc1
buffer_load_dwordx4 v[140:143], v3, s[72:75], 0 offen offset:3072 sc1
buffer_load_dwordx4 v[144:147], v4, s[72:75], 0 offen offset:0 sc1
buffer_load_dwordx4 v[148:151], v4, s[72:75], 0 offen offset:1024 sc1
buffer_load_dwordx4 v[152:155], v4, s[72:75], 0 offen offset:2048 sc1
buffer_load_dwordx4 v[156:159], v4, s[72:75], 0 offen offset:3072 sc1
s_waitcnt vmcnt(0)
v_msad_u8 v7, v128, s8, 0
v_msad_u8 v7, v129, s9, v7
v_msad_u8 v7, v130, s8, v7
v_msad_u8 v7, v131, s9, v7
v_msad_u8 v7, v132, s8, v7
v_msad_u8 v7, v133, s9, v7
v_msad_u8 v7, v134, s8, v7
v_msad_u8 v7, v135, s9, v7
v_msad_u8 v7, v136, s8, v7
v_msad_u8 v7, v137, s9, v7
v_msad_u8 v7, v138, s8, v7
v_msad_u8 v7, v139, s9, v7
v_msad_u8 v7, v140, s8, v7
v_msad_u8 v7, v141, s9, v7
v_msad_u8 v7, v142, s8, v7
v_msad_u8 v7, v143, s9, v7
v_msad_u8 v7, v144, s8, v7
v_msad_u8 v7, v145, s9, v7
v_msad_u8 v7, v146, s8, v7
v_msad_u8 v7, v147, s9, v7
v_msad_u8 v7, v148, s8, v7
v_msad_u8 v7, v149, s9, v7
v_msad_u8 v7, v150, s8, v7
v_msad_u8 v7, v151, s9, v7
v_msad_u8 v7, v152, s8, v7
v_msad_u8 v7, v153, s9, v7
v_msad_u8 v7, v154, s8, v7
v_msad_u8 v7, v155, s9, v7
v_msad_u8 v7, v156, s8, v7
v_msad_u8 v7, v157, s9, v7
v_msad_u8 v7, v158, s8, v7
v_msad_u8 v7, v159, s9, v7
v_cmp_ne_u32 vcc, 0, v7
s_nop 1
s_cbranch_vccz L_FFN_sc_ok
s_add_u32 s95, s95, 1
s_cmp_gt_u32 s95, 0x10000
s_cbranch_scc1 L_FFN_sc_ok
s_sleep 1
s_branch L_FFN_sc
L_FFN_sc_ok:
v_add_f32 v128, v128, v132
v_add_f32 v136, v136, v140
v_add_f32 v129, v129, v133
v_add_f32 v137, v137, v141
v_add_f32 v130, v130, v134
v_add_f32 v138, v138, v142
v_add_f32 v131, v131, v135
v_add_f32 v139, v139, v143
v_add_f32 v128, v128, v136
v_add_f32 v129, v129, v137
v_add_f32 v130, v130, v138
v_add_f32 v131, v131, v139
v_cvt_pk_bf16_f32 v128, v128, v128
v_cvt_pk_bf16_f32 v129, v129, v129
v_cvt_pk_bf16_f32 v130, v130, v130
v_cvt_pk_bf16_f32 v131, v131, v131
v_and_b32 v128, 0xffff0000, v128
v_and_b32 v129, 0xffff0000, v129
v_and_b32 v130, 0xffff0000, v130
v_and_b32 v131, 0xffff0000, v131
v_add_f32 v144, v144, v148
v_add_f32 v152, v152, v156
v_add_f32 v145, v145, v149
v_add_f32 v153, v153, v157
v_add_f32 v146, v146, v150
v_add_f32 v154, v154, v158
v_add_f32 v147, v147, v151
v_add_f32 v155, v155, v159
v_add_f32 v144, v144, v152
v_add_f32 v145, v145, v153
v_add_f32 v146, v146, v154
v_add_f32 v147, v147, v155
v_cvt_pk_bf16_f32 v144, v144, v144
v_cvt_pk_bf16_f32 v145, v145, v145
v_cvt_pk_bf16_f32 v146, v146, v146
v_cvt_pk_bf16_f32 v147, v147, v147
v_and_b32 v144, 0xffff0000, v144
v_and_b32 v145, 0xffff0000, v145
v_and_b32 v146, 0xffff0000, v146
v_and_b32 v147, 0xffff0000, v147
v_add_f32 v100, 1.0, v144
v_add_f32 v101, 1.0, v145
v_add_f32 v102, 1.0, v146
v_add_f32 v103, 1.0, v147
v_cvt_pk_bf16_f32 v100, v100, v100
v_cvt_pk_bf16_f32 v101, v101, v101
v_cvt_pk_bf16_f32 v102, v102, v102
v_cvt_pk_bf16_f32 v103, v103, v103
v_and_b32 v100, 0xffff0000, v100
v_and_b32 v101, 0xffff0000, v101
v_and_b32 v102, 0xffff0000, v102
v_and_b32 v103, 0xffff0000, v103
s_mov_b32 s28, 0x07060302
v_perm_b32 v8, v101, v100, s28
v_perm_b32 v9, v103, v102, s28
ds_write_b64 v12, v[8:9] offset:2688
v_perm_b32 v8, v129, v128, s28
v_perm_b32 v9, v131, v130, s28
ds_write_b64 v12, v[8:9] offset:5376
v_lshlrev_b32 v116, 16, v120
v_and_b32 v117, 0xffff0000, v120
v_lshlrev_b32 v118, 16, v121
v_and_b32 v119, 0xffff0000, v121
s_branch L_FFN_p0
L_FFN_w5:
s_cmp_eq_u32 s4, 5
s_cbranch_scc0 L_FFN_p0
s_cmp_ge_u32 s31, 40
s_cbranch_scc1 L_FFN_p0
s_lshl_b32 s33, s31, 3
v_and_b32 v2, 7, v0
v_add_u32 v3, s33, v2
v_lshrrev_b32 v4, 6, v3
v_lshlrev_b32 v4, 12, v4
v_and_b32 v3, 63, v3
v_lshlrev_b32 v3, 4, v3
v_add_u32 v3, v3, v4
v_add_u32 v3, 106496, v3
L_FFN_gb:
buffer_load_dwordx4 v[152:155], v3, s[72:75], 0 offen offset:0 sc1
buffer_load_dwordx4 v[156:159], v3, s[72:75], 0 offen offset:1024 sc1
buffer_load_dwordx4 v[160:163], v3, s[72:75], 0 offen offset:2048 sc1
buffer_load_dwordx4 v[164:167], v3, s[72:75], 0 offen offset:3072 sc1
s_waitcnt vmcnt(0)
v_msad_u8 v7, v152, s8, 0
v_msad_u8 v7, v153, s9, v7
v_msad_u8 v7, v154, s8, v7
v_msad_u8 v7, v155, s9, v7
v_msad_u8 v7, v156, s8, v7
v_msad_u8 v7, v157, s9, v7
v_msad_u8 v7, v158, s8, v7
v_msad_u8 v7, v159, s9, v7
v_msad_u8 v7, v160, s8, v7
v_msad_u8 v7, v161, s9, v7
v_msad_u8 v7, v162, s8, v7
v_msad_u8 v7, v163, s9, v7
v_msad_u8 v7, v164, s8, v7
v_msad_u8 v7, v165, s9, v7
v_msad_u8 v7, v166, s8, v7
v_msad_u8 v7, v167, s9, v7
v_cmp_ne_u32 vcc, 0, v7
s_nop 1
s_cbranch_vccz L_FFN_gb_ok
s_add_u32 s95, s95, 1
s_cmp_gt_u32 s95, 0x10000
s_cbranch_scc1 L_FFN_gb_ok
s_sleep 1
s_branch L_FFN_gb
L_FFN_gb_ok:
v_add_f32 v152, v152, v156
v_add_f32 v160, v160, v164
v_add_f32 v153, v153, v157
v_add_f32 v161, v161, v165
v_add_f32 v154, v154, v158
v_add_f32 v162, v162, v166
v_add_f32 v155, v155, v159
v_add_f32 v163, v163, v167
v_add_f32 v152, v152, v160
v_add_f32 v153, v153, v161
v_add_f32 v154, v154, v162
v_add_f32 v155, v155, v163
v_cvt_pk_bf16_f32 v152, v152, v152
v_cvt_pk_bf16_f32 v153, v153, v153
v_cvt_pk_bf16_f32 v154, v154, v154
v_cvt_pk_bf16_f32 v155, v155, v155
v_and_b32 v152, 0xffff0000, v152
v_and_b32 v153, 0xffff0000, v153
v_and_b32 v154, 0xffff0000, v154
v_and_b32 v155, 0xffff0000, v155
L_FFN_p0:
s_waitcnt lgkmcnt(0)
s_barrier
v_lshrrev_b32 v2, 4, v0
v_and_b32 v3, 15, v0
v_lshlrev_b32 v4, 1, v2
v_xor_b32 v3, v3, v4
v_mul_u32_u24 v2, 1280, v2
v_lshlrev_b32 v3, 4, v3
v_add_u32 v3, v2, v3
s_mov_b32 s50, 1966080
s_mov_b32 s51, 0x20000
s_mul_i32 s33, s4, 5
s_mul_i32 s40, s31, 40960
s_add_u32 s29, s33, 0
s_and_b32 s30, s29, 7
s_lshr_b32 s41, s29, 3
s_lshl_b32 s41, s41, 8
s_mul_i32 s42, s30, 5120
s_add_u32 s41, s41, s42
s_add_u32 s41, s41, s40
s_lshl_b32 s30, s30, 6
s_and_b32 s30, s30, 128
v_xor_b32 v4, s30, v3
s_lshl_b32 s29, s29, 10
s_add_u32 m0, s29, 81920
s_nop 0
buffer_load_dwordx4 v4, s[48:51], s41 offen nt lds
s_add_u32 s29, s33, 1
s_and_b32 s30, s29, 7
s_lshr_b32 s41, s29, 3
s_lshl_b32 s41, s41, 8
s_mul_i32 s42, s30, 5120
s_add_u32 s41, s41, s42
s_add_u32 s41, s41, s40
s_lshl_b32 s30, s30, 6
s_and_b32 s30, s30, 128
v_xor_b32 v4, s30, v3
s_lshl_b32 s29, s29, 10
s_add_u32 m0, s29, 81920
s_nop 0
buffer_load_dwordx4 v4, s[48:51], s41 offen nt lds
s_add_u32 s29, s33, 2
s_and_b32 s30, s29, 7
s_lshr_b32 s41, s29, 3
s_lshl_b32 s41, s41, 8
s_mul_i32 s42, s30, 5120
s_add_u32 s41, s41, s42
s_add_u32 s41, s41, s40
s_lshl_b32 s30, s30, 6
s_and_b32 s30, s30, 128
v_xor_b32 v4, s30, v3
s_lshl_b32 s29, s29, 10
s_add_u32 m0, s29, 81920
s_nop 0
buffer_load_dwordx4 v4, s[48:51], s41 offen nt lds
s_add_u32 s29, s33, 3
s_and_b32 s30, s29, 7
s_lshr_b32 s41, s29, 3
s_lshl_b32 s41, s41, 8
s_mul_i32 s42, s30, 5120
s_add_u32 s41, s41, s42
s_add_u32 s41, s41, s40
s_lshl_b32 s30, s30, 6
s_and_b32 s30, s30, 128
v_xor_b32 v4, s30, v3
s_lshl_b32 s29, s29, 10
s_add_u32 m0, s29, 81920
s_nop 0
buffer_load_dwordx4 v4, s[48:51], s41 offen nt lds
s_add_u32 s29, s33, 4
s_and_b32 s30, s29, 7
s_lshr_b32 s41, s29, 3
s_lshl_b32 s41, s41, 8
s_mul_i32 s42, s30, 5120
s_add_u32 s41, s41, s42
s_add_u32 s41, s41, s40
s_lshl_b32 s30, s30, 6
s_and_b32 s30, s30, 128
v_xor_b32 v4, s30, v3
s_lshl_b32 s29, s29, 10
s_add_u32 m0, s29, 81920
s_nop 0
buffer_load_dwordx4 v4, s[48:51], s41 offen nt lds
ds_read_b128 v[76:79], v14 offset:0
ds_read_b128 v[80:83], v14 offset:64
ds_read_b128 v[84:87], v14 offset:128
ds_read_b128 v[88:91], v14 offset:192
ds_read_b128 v[92:95], v14 offset:256
s_waitcnt lgkmcnt(4)
v_mfma_f32_16x16x32_bf16 v[104:107], v[16:19], v[76:79], 0
v_mfma_f32_16x16x32_bf16 v[108:111], v[20:23], v[76:79], 0
s_waitcnt lgkmcnt(3)
v_mfma_f32_16x16x32_bf16 v[104:107], v[24:27], v[80:83], v[104:107]
v_mfma_f32_16x16x32_bf16 v[108:111], v[28:31], v[80:83], v[108:111]
s_waitcnt lgkmcnt(2)
v_mfma_f32_16x16x32_bf16 v[104:107], v[32:35], v[84:87], v[104:107]
v_mfma_f32_16x16x32_bf16 v[108:111], v[36:39], v[84:87], v[108:111]
s_waitcnt lgkmcnt(1)
v_mfma_f32_16x16x32_bf16 v[104:107], v[40:43], v[88:91], v[104:107]
v_mfma_f32_16x16x32_bf16 v[108:111], v[44:47], v[88:91], v[108:111]
s_waitcnt lgkmcnt(0)
v_mfma_f32_16x16x32_bf16 v[104:107], v[48:51], v[92:95], v[104:107]
v_mfma_f32_16x16x32_bf16 v[108:111], v[52:55], v[92:95], v[108:111]
s_mov_b32 exec_lo, 0x000f000f
s_mov_b32 exec_hi, 0x000f000f
s_nop 4
ds_write_b128 v13, v[104:107]
ds_write_b128 v13, v[108:111] offset:64
s_mov_b64 exec, -1
s_waitcnt lgkmcnt(0)
s_barrier
s_cmp_ge_u32 s4, 2
s_cbranch_scc1 L_FFN_r0d
v_bfe_u32 v2, v0, 2, 1
v_lshlrev_b32 v2, 7, v2
v_bfe_u32 v3, v0, 3, 3
v_lshlrev_b32 v3, 4, v3
v_add_u32 v2, v2, v3
v_and_b32 v15, 3, v0
v_mul_u32_u24 v3, 1088, v15
s_lshl_b32 s29, s4, 8
s_add_u32 s29, s29, 141824
v_add3_u32 v14, v2, v3, s29
ds_read_b128 v[128:131], v14
ds_read_b128 v[132:135], v14 offset:512
v_cmp_eq_u32 s[34:35], 1, v15
v_cmp_eq_u32 s[36:37], 2, v15
v_cmp_eq_u32 s[38:39], 3, v15
v_bfe_u32 v2, v0, 3, 3
v_lshlrev_b32 v2, 3, v2
v_lshlrev_b32 v3, 1, v15
s_mul_i32 s29, s4, 128
s_add_u32 s29, s29, 136192
v_add3_u32 v15, v2, v3, s29
s_waitcnt lgkmcnt(0)
v_add_f32_dpp v128, v128, v128 quad_perm:[1,0,3,2] row_mask:0xf bank_mask:0xf
v_add_f32_dpp v129, v129, v129 quad_perm:[1,0,3,2] row_mask:0xf bank_mask:0xf
v_add_f32_dpp v130, v130, v130 quad_perm:[1,0,3,2] row_mask:0xf bank_mask:0xf
v_add_f32_dpp v131, v131, v131 quad_perm:[1,0,3,2] row_mask:0xf bank_mask:0xf
v_add_f32_dpp v132, v132, v132 quad_perm:[1,0,3,2] row_mask:0xf bank_mask:0xf
v_add_f32_dpp v133, v133, v133 quad_perm:[1,0,3,2] row_mask:0xf bank_mask:0xf
v_add_f32_dpp v134, v134, v134 quad_perm:[1,0,3,2] row_mask:0xf bank_mask:0xf
v_add_f32_dpp v135, v135, v135 quad_perm:[1,0,3,2] row_mask:0xf bank_mask:0xf
v_add_f32_dpp v128, v128, v128 quad_perm:[2,3,0,1] row_mask:0xf bank_mask:0xf
v_add_f32_dpp v129, v129, v129 quad_perm:[2,3,0,1] row_mask:0xf bank_mask:0xf
v_add_f32_dpp v130, v130, v130 quad_perm:[2,3,0,1] row_mask:0xf bank_mask:0xf
v_add_f32_dpp v131, v131, v131 quad_perm:[2,3,0,1] row_mask:0xf bank_mask:0xf
v_add_f32_dpp v132, v132, v132 quad_perm:[2,3,0,1] row_mask:0xf bank_mask:0xf
v_add_f32_dpp v133, v133, v133 quad_perm:[2,3,0,1] row_mask:0xf bank_mask:0xf
v_add_f32_dpp v134, v134, v134 quad_perm:[2,3,0,1] row_mask:0xf bank_mask:0xf
v_add_f32_dpp v135, v135, v135 quad_perm:[2,3,0,1] row_mask:0xf bank_mask:0xf
v_cndmask_b32 v112, v128, v129, s[34:35]
v_cndmask_b32 v113, v132, v133, s[34:35]
v_cndmask_b32 v112, v112, v130, s[36:37]
v_cndmask_b32 v113, v113, v134, s[36:37]
v_cndmask_b32 v112, v112, v131, s[38:39]
v_cndmask_b32 v113, v113, v135, s[38:39]
L_FFN_r0d:
v_lshrrev_b32 v2, 4, v0
v_bfe_u32 v3, v0, 2, 2
v_lshlrev_b32 v8, 11, v2
v_lshlrev_b32 v4, 8, v3
v_add_u32 v8, v8, v4
v_and_b32 v4, 1, v0
v_lshlrev_b32 v4, 3, v4
v_add_u32 v8, v8, v4
v_add_u32 v8, 81920, v8
v_and_b32 v2, 1, v2
v_lshlrev_b32 v2, 2, v2
v_add_u32 v3, v3, v2
v_lshlrev_b32 v3, 1, v3
v_bfe_u32 v2, v0, 1, 1
s_mul_i32 s33, s4, 5
s_add_u32 s29, s33, 0
s_and_b32 s30, s29, 7
s_lshl_b32 s30, s30, 1
s_lshr_b32 s29, s29, 3
s_lshl_b32 s29, s29, 13
v_add_u32 v4, s30, v2
v_xor_b32 v4, v4, v3
v_lshlrev_b32 v4, 4, v4
v_add3_u32 v160, v4, v8, s29
s_add_u32 s29, s33, 1
s_and_b32 s30, s29, 7
s_lshl_b32 s30, s30, 1
s_lshr_b32 s29, s29, 3
s_lshl_b32 s29, s29, 13
v_add_u32 v4, s30, v2
v_xor_b32 v4, v4, v3
v_lshlrev_b32 v4, 4, v4
v_add3_u32 v161, v4, v8, s29
s_add_u32 s29, s33, 2
s_and_b32 s30, s29, 7
s_lshl_b32 s30, s30, 1
s_lshr_b32 s29, s29, 3
s_lshl_b32 s29, s29, 13
v_add_u32 v4, s30, v2
v_xor_b32 v4, v4, v3
v_lshlrev_b32 v4, 4, v4
v_add3_u32 v162, v4, v8, s29
s_add_u32 s29, s33, 3
s_and_b32 s30, s29, 7
s_lshl_b32 s30, s30, 1
s_lshr_b32 s29, s29, 3
s_lshl_b32 s29, s29, 13
v_add_u32 v4, s30, v2
v_xor_b32 v4, v4, v3
v_lshlrev_b32 v4, 4, v4
v_add3_u32 v163, v4, v8, s29
s_add_u32 s29, s33, 4
s_and_b32 s30, s29, 7
s_lshl_b32 s30, s30, 1
s_lshr_b32 s29, s29, 3
s_lshl_b32 s29, s29, 13
v_add_u32 v4, s30, v2
v_xor_b32 v4, v4, v3
v_lshlrev_b32 v4, 4, v4
v_add3_u32 v164, v4, v8, s29
s_mul_i32 s29, s4, 40
s_add_u32 s29, s29, 123520
v_mov_b32 v165, s29
s_waitcnt vmcnt(0)
s_barrier
ds_read_b64_tr_b16 v[56:57], v160
ds_read_b64_tr_b16 v[58:59], v160 offset:1024
ds_read_b64_tr_b16 v[60:61], v161
ds_read_b64_tr_b16 v[62:63], v161 offset:1024
ds_read_b64_tr_b16 v[64:65], v162
ds_read_b64_tr_b16 v[66:67], v162 offset:1024
ds_read_b64_tr_b16 v[68:69], v163
ds_read_b64_tr_b16 v[70:71], v163 offset:1024
ds_read_b64_tr_b16 v[72:73], v164
ds_read_b64_tr_b16 v[74:75], v164 offset:1024
v_and_b32 v10, 1, v0
v_mul_u32_u24 v10, 128, v10
v_lshrrev_b32 v2, 4, v0
v_lshlrev_b32 v2, 4, v2
v_add_u32 v10, v10, v2
v_add_u32 v10, 136192, v10
v_and_b32 v9, 1, v0
v_lshlrev_b32 v9, 9, v9
v_add_u32 v9, v9, v2
v_bfe_u32 v3, v0, 2, 2
v_and_b32 v4, 2, v0
v_cmp_ne_u32 vcc, 0, v4
s_nop 1
v_cndmask_b32 v3, v3, 4, vcc
s_mul_i32 s29, s4, 5
v_add_u32 v3, s29, v3
v_lshrrev_b32 v4, 3, v3
v_lshlrev_b32 v4, 10, v4
v_and_b32 v3, 7, v3
v_lshlrev_b32 v3, 6, v3
v_add3_u32 v9, v9, v3, v4
s_mul_i32 s29, s31, 5120
s_add_u32 s29, s29, 655360
v_add_u32 v9, s29, v9
s_cmp_ge_u32 s4, 5
s_cbranch_scc1 L_FFN_b1
v_lshlrev_b32 v2, 4, v0
s_lshl_b32 s29, s4, 10
s_add_u32 s30, s29, 136448
v_add_u32 v8, s30, v2
s_add_u32 s29, s29, 589824
v_add_u32 v3, s29, v2
v_lshrrev_b32 v6, 5, v0
v_mul_u32_u24 v6, 40, v6
s_lshl_b32 s29, s4, 3
s_add_u32 s29, s29, 123520
v_add_u32 v6, s29, v6
s_mov_b32 s30, 5120
L_FFN_poll:
v_mov_b32 v4, v3
buffer_load_dwordx4 v[128:131], v4, s[72:75], 0 offen sc1
v_add_u32 v4, s30, v4
buffer_load_dwordx4 v[132:135], v4, s[72:75], 0 offen sc1
v_add_u32 v4, s30, v4
buffer_load_dwordx4 v[136:139], v4, s[72:75], 0 offen sc1
v_add_u32 v4, s30, v4
buffer_load_dwordx4 v[140:143], v4, s[72:75], 0 offen sc1
v_add_u32 v4, s30, v4
buffer_load_dwordx4 v[144:147], v4, s[72:75], 0 offen sc1
v_add_u32 v4, s30, v4
buffer_load_dwordx4 v[148:151], v4, s[72:75], 0 offen sc1
v_add_u32 v4, s30, v4
buffer_load_dwordx4 v[152:155], v4, s[72:75], 0 offen sc1
v_add_u32 v4, s30, v4
buffer_load_dwordx4 v[156:159], v4, s[72:75], 0 offen sc1
s_waitcnt vmcnt(0)
v_msad_u8 v7, v128, s8, 0
v_msad_u8 v7, v129, s9, v7
v_msad_u8 v7, v130, s8, v7
v_msad_u8 v7, v131, s9, v7
v_msad_u8 v98, v144, s8, 0
v_msad_u8 v98, v145, s9, v98
v_msad_u8 v98, v146, s8, v98
v_msad_u8 v98, v147, s9, v98
v_msad_u8 v7, v132, s8, v7
v_msad_u8 v7, v133, s9, v7
v_msad_u8 v7, v134, s8, v7
v_msad_u8 v7, v135, s9, v7
v_msad_u8 v98, v148, s8, v98
v_msad_u8 v98, v149, s9, v98
v_msad_u8 v98, v150, s8, v98
v_msad_u8 v98, v151, s9, v98
v_msad_u8 v7, v136, s8, v7
v_msad_u8 v7, v137, s9, v7
v_msad_u8 v7, v138, s8, v7
v_msad_u8 v7, v139, s9, v7
v_msad_u8 v98, v152, s8, v98
v_msad_u8 v98, v153, s9, v98
v_msad_u8 v98, v154, s8, v98
v_msad_u8 v98, v155, s9, v98
v_msad_u8 v7, v140, s8, v7
v_msad_u8 v7, v141, s9, v7
v_msad_u8 v7, v142, s8, v7
v_msad_u8 v7, v143, s9, v7
v_msad_u8 v98, v156, s8, v98
v_msad_u8 v98, v157, s9, v98
v_msad_u8 v98, v158, s8, v98
v_msad_u8 v98, v159, s9, v98
v_or_b32 v7, v7, v98
v_cmp_ne_u32 vcc, 0, v7
s_nop 1
s_cbranch_vccz L_FFN_poll_ok
s_add_u32 s95, s95, 1
s_cmp_gt_u32 s95, 0x10000
s_cbranch_scc1 L_FFN_poll_ok
s_branch L_FFN_poll
L_FFN_poll_ok:
v_pk_add_f32 v[128:129], v[128:129], v[144:145]
v_pk_add_f32 v[130:131], v[130:131], v[146:147]
v_pk_add_f32 v[132:133], v[132:133], v[148:149]
v_pk_add_f32 v[134:135], v[134:135], v[150:151]
v_pk_add_f32 v[136:137], v[136:137], v[152:153]
v_pk_add_f32 v[138:139], v[138:139], v[154:155]
v_pk_add_f32 v[140:141], v[140:141], v[156:157]
v_pk_add_f32 v[142:143], v[142:143], v[158:159]
v_pk_add_f32 v[128:129], v[128:129], v[136:137]
v_pk_add_f32 v[130:131], v[130:131], v[138:139]
v_pk_add_f32 v[132:133], v[132:133], v[140:141]
v_pk_add_f32 v[134:135], v[134:135], v[142:143]
v_pk_add_f32 v[128:129], v[128:129], v[132:133]
v_pk_add_f32 v[130:131], v[130:131], v[134:135]
v_pk_add_f32 v[116:117], v[116:117], v[128:129]
v_pk_add_f32 v[118:119], v[118:119], v[130:131]
v_pk_mul_f32 v[128:129], v[116:117], v[100:101]
v_pk_mul_f32 v[130:131], v[118:119], v[102:103]
v_add_f32 v132, v116, v117
v_add_f32 v134, v118, v119
v_mul_f32 v133, v116, v116
v_cvt_pk_bf16_f32 v128, v128, v129
v_cvt_pk_bf16_f32 v129, v130, v131
v_add_f32 v132, v132, v134
v_fmac_f32 v133, v117, v117
ds_write_b64 v12, v[128:129]
v_fmac_f32 v133, v118, v118
ds_write_b128 v8, v[116:119]
v_fmac_f32 v133, v119, v119
v_add_f32_dpp v132, v132, v132 row_ror:8 row_mask:0xf bank_mask:0xf
s_nop 0
v_add_f32_dpp v133, v133, v133 row_ror:8 row_mask:0xf bank_mask:0xf
v_add_f32_dpp v132, v132, v132 row_ror:4 row_mask:0xf bank_mask:0xf
s_nop 0
v_add_f32_dpp v133, v133, v133 row_ror:4 row_mask:0xf bank_mask:0xf
v_add_f32_dpp v132, v132, v132 row_ror:2 row_mask:0xf bank_mask:0xf
s_nop 0
v_add_f32_dpp v133, v133, v133 row_ror:2 row_mask:0xf bank_mask:0xf
v_add_f32_dpp v132, v132, v132 row_ror:1 row_mask:0xf bank_mask:0xf
s_nop 0
v_add_f32_dpp v133, v133, v133 row_ror:1 row_mask:0xf bank_mask:0xf
v_mov_b32 v134, v132
v_mov_b32 v135, v133
s_nop 0
v_permlane16_swap_b32 v132, v134
v_permlane16_swap_b32 v133, v135
v_add_f32 v132, v132, v134
v_add_f32 v133, v133, v135
s_mov_b32 exec_lo, 1
s_mov_b32 exec_hi, 1
ds_write_b64 v6, v[132:133]
s_mov_b64 exec, -1
L_FFN_b1:
s_waitcnt vmcnt(0) lgkmcnt(0)
s_barrier
s_cmp_ge_u32 s4, 2
s_cbranch_scc1 L_FFN_nst
ds_read2_b64 v[136:139], v165 offset0:0 offset1:1
ds_read2_b64 v[140:143], v165 offset0:2 offset1:3
ds_read_b64 v[144:145], v165 offset:32
L_FFN_nst:
ds_read_b128 v[76:79], v11 offset:0
ds_read_b128 v[80:83], v11 offset:64
ds_read_b128 v[84:87], v11 offset:128
ds_read_b128 v[88:91], v11 offset:192
ds_read_b128 v[92:95], v11 offset:256
s_mov_b32 s28, 0x3acccccd
s_waitcnt lgkmcnt(4)
v_pk_add_f32 v[136:137], v[136:137], v[138:139]
v_pk_add_f32 v[140:141], v[140:141], v[142:143]
v_mfma_f32_16x16x32_bf16 v[104:107], v[16:19], v[76:79], 0
v_mfma_f32_16x16x32_bf16 v[108:111], v[20:23], v[76:79], 0
v_pk_add_f32 v[136:137], v[136:137], v[144:145]
v_pk_add_f32 v[136:137], v[136:137], v[140:141]
s_waitcnt lgkmcnt(3)
v_mfma_f32_16x16x32_bf16 v[104:107], v[24:27], v[80:83], v[104:107]
v_mfma_f32_16x16x32_bf16 v[108:111], v[28:31], v[80:83], v[108:111]
v_mul_f32 v136, s28, v136
v_mul_f32 v137, s28, v137
s_waitcnt lgkmcnt(2)
v_mfma_f32_16x16x32_bf16 v[104:107], v[32:35], v[84:87], v[104:107]
v_mfma_f32_16x16x32_bf16 v[108:111], v[36:39], v[84:87], v[108:111]
v_fma_f32 v137, -v136, v136, v137
v_max_f32 v137, 0, v137
v_add_f32 v137, 0x3727c5ac, v137
s_waitcnt lgkmcnt(1)
v_mfma_f32_16x16x32_bf16 v[104:107], v[40:43], v[88:91], v[104:107]
v_mfma_f32_16x16x32_bf16 v[108:111], v[44:47], v[88:91], v[108:111]
v_rsq_f32 v137, v137
s_waitcnt lgkmcnt(0)
v_mfma_f32_16x16x32_bf16 v[104:107], v[48:51], v[92:95], v[104:107]
v_mfma_f32_16x16x32_bf16 v[108:111], v[52:55], v[92:95], v[108:111]
s_mov_b32 exec_lo, 0x000f000f
s_mov_b32 exec_hi, 0x000f000f
s_nop 4
ds_write_b128 v13, v[104:107]
ds_write_b128 v13, v[108:111] offset:64
s_mov_b64 exec, -1
s_waitcnt lgkmcnt(0)
s_barrier
s_cmp_ge_u32 s4, 2
s_cbranch_scc1 L_FFN_b3
ds_read_b128 v[128:131], v14
s_mov_b32 s28, 0x3d372713
s_waitcnt lgkmcnt(0)
v_add_f32_dpp v128, v128, v128 quad_perm:[1,0,3,2] row_mask:0xf bank_mask:0xf
v_add_f32_dpp v129, v129, v129 quad_perm:[1,0,3,2] row_mask:0xf bank_mask:0xf
v_add_f32_dpp v130, v130, v130 quad_perm:[1,0,3,2] row_mask:0xf bank_mask:0xf
v_add_f32_dpp v131, v131, v131 quad_perm:[1,0,3,2] row_mask:0xf bank_mask:0xf
v_add_f32_dpp v128, v128, v128 quad_perm:[2,3,0,1] row_mask:0xf bank_mask:0xf
v_add_f32_dpp v129, v129, v129 quad_perm:[2,3,0,1] row_mask:0xf bank_mask:0xf
v_add_f32_dpp v130, v130, v130 quad_perm:[2,3,0,1] row_mask:0xf bank_mask:0xf
v_add_f32_dpp v131, v131, v131 quad_perm:[2,3,0,1] row_mask:0xf bank_mask:0xf
v_cndmask_b32 v128, v128, v129, s[34:35]
v_cndmask_b32 v128, v128, v130, s[36:37]
v_cndmask_b32 v128, v128, v131, s[38:39]
v_fma_f32 v128, -v136, v112, v128
v_fma_f32 v128, v137, v128, v113
v_mul_f32 v129, v128, v128
s_nop 0
v_mov_b32_dpp v130, v128 row_shl:4 row_mask:0xf bank_mask:0xf
v_mul_f32 v129, v129, v128
v_fma_f32 v129, v129, s28, v128
v_mul_f32 v129, 0xc0135761, v129
v_exp_f32 v129, v129
v_mul_f32 v128, v128, v130
v_add_f32 v129, 1.0, v129
v_rcp_f32 v129, v129
s_nop 0
v_mul_f32 v128, v128, v129
v_cvt_pk_bf16_f32 v128, v128, v128
s_mov_b32 exec_lo, 0x0f0f0f0f
s_mov_b32 exec_hi, 0x0f0f0f0f
ds_write_b16 v15, v128
s_mov_b64 exec, -1
L_FFN_b3:
s_waitcnt lgkmcnt(0)
s_barrier
ds_read_b128 v[76:79], v10
s_mul_i32 s33, s4, 5
s_waitcnt lgkmcnt(0)
v_mfma_f32_16x16x32_bf16 v[128:131], v[56:59], v[76:79], 0
v_mfma_f32_16x16x32_bf16 v[132:135], v[60:63], v[76:79], 0
v_mfma_f32_16x16x32_bf16 v[136:139], v[64:67], v[76:79], 0
v_mfma_f32_16x16x32_bf16 v[140:143], v[68:71], v[76:79], 0
v_mfma_f32_16x16x32_bf16 v[144:147], v[72:75], v[76:79], 0
s_nop 7
v_mov_b32_dpp v128, v144 row_shr:2 row_mask:0xf bank_mask:0x1
v_mov_b32_dpp v129, v145 row_shr:2 row_mask:0xf bank_mask:0x1
v_mov_b32_dpp v130, v146 row_shr:2 row_mask:0xf bank_mask:0x1
v_mov_b32_dpp v131, v147 row_shr:2 row_mask:0xf bank_mask:0x1
v_mov_b32_dpp v128, v132 row_shr:4 row_mask:0xf bank_mask:0x2
v_mov_b32_dpp v129, v133 row_shr:4 row_mask:0xf bank_mask:0x2
v_mov_b32_dpp v130, v134 row_shr:4 row_mask:0xf bank_mask:0x2
v_mov_b32_dpp v131, v135 row_shr:4 row_mask:0xf bank_mask:0x2
v_mov_b32_dpp v128, v136 row_shr:8 row_mask:0xf bank_mask:0x4
v_mov_b32_dpp v129, v137 row_shr:8 row_mask:0xf bank_mask:0x4
v_mov_b32_dpp v130, v138 row_shr:8 row_mask:0xf bank_mask:0x4
v_mov_b32_dpp v131, v139 row_shr:8 row_mask:0xf bank_mask:0x4
v_mov_b32_dpp v128, v140 row_shr:12 row_mask:0xf bank_mask:0x8
v_mov_b32_dpp v129, v141 row_shr:12 row_mask:0xf bank_mask:0x8
v_mov_b32_dpp v130, v142 row_shr:12 row_mask:0xf bank_mask:0x8
v_mov_b32_dpp v131, v143 row_shr:12 row_mask:0xf bank_mask:0x8
s_mov_b32 exec_lo, 0x333f333f
s_mov_b32 exec_hi, 0x333f333f
v_and_or_b32 v128, v128, v5, s8
v_and_or_b32 v129, v129, v5, s9
v_and_or_b32 v130, v130, v5, s8
v_and_or_b32 v131, v131, v5, s9
buffer_store_dwordx4 v[128:131], v9, s[72:75], 0 offen sc1
s_mov_b64 exec, -1
s_cmp_eq_u32 s4, 5
s_cbranch_scc0 L_exit
s_cmp_ge_u32 s31, 40
s_cbranch_scc1 L_exit
L_FIN_go:
v_lshrrev_b32 v2, 3, v0
v_mul_u32_u24 v2, 30720, v2
v_and_b32 v3, 7, v0
v_lshlrev_b32 v3, 4, v3
v_add_u32 v2, v2, v3
s_lshl_b32 s29, s31, 7
s_add_u32 s30, s29, 655360
v_add_u32 v2, s30, v2
s_add_u32 s29, s29, 136448
v_add_u32 v4, s29, v3
ds_read_b128 v[40:43], v4
s_lshl_b32 s29, s31, 3
v_add_u32 v8, s29, v0
v_lshrrev_b32 v3, 6, v8
v_lshlrev_b32 v3, 8, v3
v_bfe_u32 v4, v8, 5, 1
v_mul_u32_u24 v4, 1280, v4
v_add_u32 v3, v3, v4
v_and_b32 v4, 31, v8
v_lshlrev_b32 v4, 3, v4
v_add_u32 v8, v3, v4
s_mov_b32 s30, 5120
L_FIN_poll:
v_mov_b32 v4, v2
buffer_load_dwordx4 v[16:19], v4, s[72:75], 0 offen sc1
v_add_u32 v4, s30, v4
buffer_load_dwordx4 v[20:23], v4, s[72:75], 0 offen sc1
v_add_u32 v4, s30, v4
buffer_load_dwordx4 v[24:27], v4, s[72:75], 0 offen sc1
v_add_u32 v4, s30, v4
buffer_load_dwordx4 v[28:31], v4, s[72:75], 0 offen sc1
v_add_u32 v4, s30, v4
buffer_load_dwordx4 v[32:35], v4, s[72:75], 0 offen sc1
v_add_u32 v4, s30, v4
buffer_load_dwordx4 v[36:39], v4, s[72:75], 0 offen sc1
s_waitcnt vmcnt(0)
v_msad_u8 v7, v16, s8, 0
v_msad_u8 v7, v17, s9, v7
v_msad_u8 v7, v18, s8, v7
v_msad_u8 v7, v19, s9, v7
v_msad_u8 v6, v28, s8, 0
v_msad_u8 v6, v29, s9, v6
v_msad_u8 v6, v30, s8, v6
v_msad_u8 v6, v31, s9, v6
v_msad_u8 v7, v20, s8, v7
v_msad_u8 v7, v21, s9, v7
v_msad_u8 v7, v22, s8, v7
v_msad_u8 v7, v23, s9, v7
v_msad_u8 v6, v32, s8, v6
v_msad_u8 v6, v33, s9, v6
v_msad_u8 v6, v34, s8, v6
v_msad_u8 v6, v35, s9, v6
v_msad_u8 v7, v24, s8, v7
v_msad_u8 v7, v25, s9, v7
v_msad_u8 v7, v26, s8, v7
v_msad_u8 v7, v27, s9, v7
v_msad_u8 v6, v36, s8, v6
v_msad_u8 v6, v37, s9, v6
v_msad_u8 v6, v38, s8, v6
v_msad_u8 v6, v39, s9, v6
v_or_b32 v7, v7, v6
v_cmp_ne_u32 vcc, 0, v7
s_nop 1
s_cbranch_vccz L_FIN_poll_ok
s_add_u32 s95, s95, 1
s_cmp_gt_u32 s95, 0x10000
s_cbranch_scc1 L_FIN_poll_ok
s_branch L_FIN_poll
L_FIN_poll_ok:
v_pk_add_f32 v[16:17], v[16:17], v[20:21]
v_pk_add_f32 v[18:19], v[18:19], v[22:23]
v_pk_add_f32 v[24:25], v[24:25], v[28:29]
v_pk_add_f32 v[26:27], v[26:27], v[30:31]
v_pk_add_f32 v[32:33], v[32:33], v[36:37]
v_pk_add_f32 v[34:35], v[34:35], v[38:39]
v_pk_add_f32 v[16:17], v[16:17], v[24:25]
v_pk_add_f32 v[18:19], v[18:19], v[26:27]
v_pk_add_f32 v[16:17], v[16:17], v[32:33]
v_pk_add_f32 v[18:19], v[18:19], v[34:35]
s_nop 0
v_add_f32_dpp v16, v16, v16 row_ror:8 row_mask:0xf bank_mask:0xf
v_add_f32_dpp v17, v17, v17 row_ror:8 row_mask:0xf bank_mask:0xf
v_add_f32_dpp v18, v18, v18 row_ror:8 row_mask:0xf bank_mask:0xf
v_add_f32_dpp v19, v19, v19 row_ror:8 row_mask:0xf bank_mask:0xf
v_mov_b32 v20, v16
v_mov_b32 v21, v17
v_mov_b32 v22, v18
v_mov_b32 v23, v19
v_permlane16_swap_b32 v16, v20
v_permlane16_swap_b32 v17, v21
v_permlane16_swap_b32 v18, v22
v_permlane16_swap_b32 v19, v23
v_add_f32 v16, v16, v20
v_add_f32 v17, v17, v21
v_add_f32 v18, v18, v22
v_add_f32 v19, v19, v23
v_mov_b32 v20, v16
v_mov_b32 v21, v17
v_mov_b32 v22, v18
v_mov_b32 v23, v19
v_permlane32_swap_b32 v16, v20
v_permlane32_swap_b32 v17, v21
v_permlane32_swap_b32 v18, v22
v_permlane32_swap_b32 v19, v23
v_add_f32 v16, v16, v20
v_add_f32 v17, v17, v21
v_add_f32 v18, v18, v22
v_add_f32 v19, v19, v23
s_waitcnt lgkmcnt(0)
v_fma_f32 v16, v16, v152, v40
v_fma_f32 v17, v17, v153, v41
v_fma_f32 v18, v18, v154, v42
v_fma_f32 v19, v19, v155, v43
v_cvt_pk_bf16_f32 v16, v16, v17
v_cvt_pk_bf16_f32 v17, v18, v19
s_mov_b64 exec, 0xff
global_store_dwordx2 v8, v[16:17], s[46:47]
s_cmp_eq_u32 s31, 0
s_cbranch_scc0 L_FIN_done
s_mov_b64 exec, 1
v_mov_b32 v2, 0
v_mov_b32 v3, s7
buffer_store_dword v3, v2, s[72:75], 0 offen
L_FIN_done:
s_endpgm
L_LH:
s_setprio 3
v_lshrrev_b32 v2, 3, v0
v_and_b32 v3, 7, v0
v_and_b32 v4, 2, v2
v_xor_b32 v3, v3, v4
v_xor_b32 v4, 4, v3
s_cmp_lt_u32 s6, 10
s_cbranch_scc0 L_L_ffn
v_mul_u32_u24 v2, 1280, v2
v_lshlrev_b32 v3, 4, v3
v_lshlrev_b32 v4, 4, v4
v_add_u32 v3, v2, v3
v_add_u32 v4, v2, v4
s_mov_b32 s42, 7864320
s_mov_b32 s43, 0x20000
s_mul_i32 s45, s5, 983040
s_lshl_b32 s46, s6, 7
s_add_u32 s45, s45, s46
s_mov_b32 m0, 0
s_movk_i32 s46, 48
s_waitcnt lgkmcnt(0)
s_mov_b64 s[40:41], s[84:85]
s_mov_b32 s72, s10
s_mov_b32 s73, s11
s_mov_b32 s74, 0x200000
s_mov_b32 s75, 0x20000
s_barrier
L_L_wo_loop:
buffer_load_dwordx4 v3, s[40:43], s45 offen nt lds
s_add_u32 s45, s45, 10240
s_add_u32 m0, m0, 1024
s_waitcnt vmcnt(19)
buffer_load_dwordx4 v4, s[40:43], s45 offen nt lds
s_add_u32 s45, s45, 10240
s_add_u32 m0, m0, 1024
s_waitcnt vmcnt(19)
s_sub_u32 s46, s46, 1
s_cmp_lg_u32 s46, 0
s_cbranch_scc1 L_L_wo_loop
s_waitcnt vmcnt(0)
s_endpgm
L_L_ffn:
s_sub_u32 s31, s6, 10
s_lshr_b32 s3, s31, 1
s_mov_b32 s30, 4224
s_lshl_b32 s29, s5, 1
s_lshr_b32 s30, s30, s29
s_and_b32 s30, s30, 3
s_add_u32 s3, s3, s30
s_cmp_ge_u32 s3, 3
s_cselect_b32 s30, 3, 0
s_sub_u32 s3, s3, s30
s_lshl_b32 s3, s3, 1
s_and_b32 s31, s31, 1
s_add_u32 s31, s31, s3
s_mul_i32 s3, s5, 6
s_add_u32 s31, s31, s3
v_mul_u32_u24 v2, 3072, v2
s_lshl_b32 s29, s31, 6
v_add_u32 v2, s29, v2
v_and_b32 v6, 3, v3
v_lshlrev_b32 v6, 4, v6
v_add_u32 v6, v6, v2
v_and_b32 v7, 3, v4
v_lshlrev_b32 v7, 4, v7
v_add_u32 v7, v7, v2
v_add_u32 v7, 24576, v7
v_cmp_lt_u32 vcc, 3, v3
v_cmp_lt_u32 s[34:35], 3, v4
s_waitcnt lgkmcnt(0)
s_mov_b32 s72, s10
s_mov_b32 s73, s11
s_mov_b32 s74, 0x200000
s_mov_b32 s75, 0x20000
v_mov_b32 v8, s88
v_mov_b32 v9, s89
v_mov_b32 v12, s90
v_mov_b32 v13, s91
v_cndmask_b32 v10, v8, v12, s[34:35]
v_cndmask_b32 v11, v9, v13, s[34:35]
v_cndmask_b32 v8, v8, v12, vcc
v_cndmask_b32 v9, v9, v13, vcc
v_add_co_u32 v8, vcc, v8, v6
s_nop 1
v_addc_co_u32 v9, vcc, 0, v9, vcc
v_add_co_u32 v10, vcc, v10, v7
s_nop 1
v_addc_co_u32 v11, vcc, 0, v11, vcc
s_mov_b32 m0, 0
s_movk_i32 s46, 40
s_mov_b32 s44, 49152
s_barrier
L_L_gu_loop:
global_load_lds_dwordx4 v[8:9], off nt
v_add_co_u32 v8, vcc, s44, v8
s_nop 1
v_addc_co_u32 v9, vcc, 0, v9, vcc
s_add_u32 m0, m0, 1024
s_waitcnt vmcnt(59)
global_load_lds_dwordx4 v[10:11], off nt
v_add_co_u32 v10, vcc, s44, v10
s_nop 1
v_addc_co_u32 v11, vcc, 0, v11, vcc
s_add_u32 m0, m0, 1024
s_waitcnt vmcnt(59)
s_sub_u32 s46, s46, 1
s_cmp_lg_u32 s46, 0
s_cbranch_scc1 L_L_gu_loop
s_nop 0
s_waitcnt vmcnt(0)
s_endpgm
L_F:
s_cmp_eq_u32 s4, 8
s_cbranch_scc0 L_F_nz
v_mov_b32 v2, 123480
v_mov_b32 v3, 0
ds_write2_b32 v2, v3, v3 offset0:0 offset1:1
L_F_nz:
s_cmp_lt_u32 s6, 16
s_cbranch_scc0 L_FW
s_cmp_eq_u32 s4, 9
s_cbranch_scc1 L_LH
s_waitcnt lgkmcnt(0)
s_barrier
s_cmp_ge_u32 s6, 10
s_cbranch_scc0 L_F_nocpf
s_getpc_b64 s[12:13]
L_pc:
s_sub_u32 s12, s12, L_pc-adaLN_cond__sliding_block_cached__geglu_ffn__decode_kernel
s_subb_u32 s13, s13, 0
s_and_b32 s13, s13, 0xffff
s_mov_b32 s14, L_exit-adaLN_cond__sliding_block_cached__geglu_ffn__decode_kernel
s_mov_b32 s15, 0x20000
v_lshlrev_b32 v2, 4, v0
buffer_load_dwordx4 v[16:19], v2, s[12:15], 0 offen
v_add_u32 v2, 1024, v2
buffer_load_dwordx4 v[16:19], v2, s[12:15], 0 offen
v_add_u32 v2, 1024, v2
buffer_load_dwordx4 v[16:19], v2, s[12:15], 0 offen
v_add_u32 v2, 1024, v2
buffer_load_dwordx4 v[16:19], v2, s[12:15], 0 offen
v_add_u32 v2, 1024, v2
buffer_load_dwordx4 v[16:19], v2, s[12:15], 0 offen
v_add_u32 v2, 1024, v2
buffer_load_dwordx4 v[16:19], v2, s[12:15], 0 offen
v_add_u32 v2, 1024, v2
buffer_load_dwordx4 v[16:19], v2, s[12:15], 0 offen
v_add_u32 v2, 1024, v2
buffer_load_dwordx4 v[16:19], v2, s[12:15], 0 offen
v_add_u32 v2, 1024, v2
buffer_load_dwordx4 v[16:19], v2, s[12:15], 0 offen
v_add_u32 v2, 1024, v2
buffer_load_dwordx4 v[16:19], v2, s[12:15], 0 offen
v_add_u32 v2, 1024, v2
buffer_load_dwordx4 v[16:19], v2, s[12:15], 0 offen
v_add_u32 v2, 1024, v2
buffer_load_dwordx4 v[16:19], v2, s[12:15], 0 offen
v_add_u32 v2, 1024, v2
buffer_load_dwordx4 v[16:19], v2, s[12:15], 0 offen
v_add_u32 v2, 1024, v2
buffer_load_dwordx4 v[16:19], v2, s[12:15], 0 offen
v_add_u32 v2, 1024, v2
buffer_load_dwordx4 v[16:19], v2, s[12:15], 0 offen
v_add_u32 v2, 1024, v2
buffer_load_dwordx4 v[16:19], v2, s[12:15], 0 offen
v_add_u32 v2, 1024, v2
L_F_nocpf:
s_waitcnt lgkmcnt(0)
s_load_dword s7, s[10:11], 0
s_mov_b32 s72, s10
s_mov_b32 s73, s11
s_mov_b32 s74, 0x200000
s_mov_b32 s75, 0x20000
v_mov_b32 v5, 0xffffff00
s_waitcnt lgkmcnt(0)
s_add_u32 s7, s7, 1
s_and_b32 s8, s7, 0x7f
s_add_u32 s8, s8, 1
s_add_u32 s9, s8, 127
s_branch L_F_gath
L_FW:
s_setprio 3
s_sub_u32 s30, s6, 16
s_cmp_lt_u32 s30, 5
s_cselect_b32 s31, 1, 0
s_sub_u32 s38, s4, 8
s_cmp_eq_u32 s31, 1
s_cbranch_scc0 L_FW_unit
s_cmp_eq_u32 s38, 1
s_cbranch_scc0 L_FW_unit
s_barrier
s_barrier
s_barrier
L_FW_unit:
s_cmp_eq_u32 s31, 1
s_cbranch_scc0 L_FW_uq
s_mov_b32 s20, 1
s_mul_i32 s34, s5, 5
s_add_u32 s34, s34, s30
s_cmp_eq_u32 s38, 0
s_cbranch_scc1 L_FW_um
s_lshl_b32 s34, s34, 1
s_lshr_b32 s35, s38, 1
s_add_u32 s34, s34, s35
s_add_u32 s34, s34, 40
L_FW_um:
s_lshr_b32 s21, s34, 2
s_and_b32 s22, s34, 3
s_branch L_FW_ud
L_FW_uq:
s_sub_u32 s34, s30, 5
s_lshl_b32 s34, s34, 1
s_cmp_eq_u32 s30, 15
s_cselect_b32 s35, 1, 0
s_add_u32 s34, s34, s35
s_add_u32 s34, s34, s38
s_mul_i32 s22, s34, 43
s_lshr_b32 s22, s22, 8
s_mul_i32 s21, s22, 6
s_sub_u32 s21, s34, s21
s_mul_i32 s3, s5, 6
s_add_u32 s21, s21, s3
s_mov_b32 s20, 2
L_FW_ud:
s_mul_i32 s23, s38, 40960
s_mul_i32 s24, s38, 1280
s_add_u32 s24, s24, 123904
s_lshl_b32 s54, s21, 2
s_add_u32 s54, s54, s22
s_lshl_b32 s54, s54, 10
s_cmp_eq_u32 s20, 2
s_mov_b32 s34, 4096
s_cselect_b32 s34, 131072, s34
s_add_u32 s54, s54, s34
s_lshl_b32 s34, s38, 2
s_add_u32 s34, s34, 123776
v_mov_b32 v2, s34
v_mov_b32 v3, s54
s_mov_b64 exec, 1
ds_write_b32 v2, v3
s_mov_b64 exec, -1
s_waitcnt lgkmcnt(0)
s_load_dword s7, s[10:11], 0
s_mov_b64 s[12:13], s[82:83]
s_mov_b64 s[14:15], s[68:69]
s_mov_b64 s[16:17], s[66:67]
s_mov_b64 s[18:19], s[76:77]
s_mov_b32 s72, s10
s_mov_b32 s73, s11
s_mov_b32 s74, 0x200000
s_mov_b32 s75, 0x20000
s_cmp_eq_u32 s20, 1
s_cbranch_scc1 L_FW_nox
s_cmp_eq_u32 s38, 0
s_cbranch_scc0 L_FW_nopf
v_lshrrev_b32 v2, 5, v0
v_mul_u32_u24 v2, 1280, v2
v_and_b32 v3, 31, v0
v_lshlrev_b32 v3, 3, v3
v_add_u32 v2, v2, v3
global_load_dwordx2 v[8:9], v2, s[18:19] offset:0
global_load_dwordx2 v[10:11], v2, s[18:19] offset:256
global_load_dwordx2 v[12:13], v2, s[18:19] offset:512
global_load_dwordx2 v[14:15], v2, s[18:19] offset:768
global_load_dwordx2 v[16:17], v2, s[18:19] offset:1024
L_FW_nox:
s_cmp_eq_u32 s20, 2
s_cselect_b32 s36, s18, s16
s_cselect_b32 s37, s19, s17
s_mul_i32 s33, s22, 320
v_lshlrev_b32 v2, 3, v0
v_add_u32 v2, s33, v2
s_mov_b32 exec_lo, -1
s_mov_b32 exec_hi, 0xff
global_load_dwordx2 v[18:19], v2, s[36:37]
global_load_dwordx2 v[20:21], v2, s[36:37] offset:1280
s_mov_b64 exec, -1
L_FW_nopf:
s_cmp_eq_u32 s20, 2
s_cselect_b32 s40, s12, s14
s_cselect_b32 s41, s13, s15
s_mov_b32 s42, 4915200
s_cselect_b32 s42, 7864320, s42
s_mov_b32 s43, 0x20000
s_movk_i32 s44, 7680
s_cselect_b32 s44, 12288, s44
v_lshrrev_b32 v22, 4, v0
v_mul_lo_u32 v22, s44, v22
v_and_b32 v3, 15, v0
v_lshlrev_b32 v3, 4, v3
v_add_u32 v22, v22, v3
s_mul_i32 s45, s22, 160
s_mul_i32 s45, s45, s44
s_lshl_b32 s46, s21, 8
s_add_u32 s45, s45, s46
s_lshl_b32 s44, s44, 2
s_mov_b32 m0, s23
s_movk_i32 s46, 40
L_FW_dma:
buffer_load_dwordx4 v22, s[40:43], s45 offen nt lds
s_add_u32 m0, m0, 1024
s_add_u32 s45, s45, s44
buffer_load_dwordx4 v22, s[40:43], s45 offen nt lds
s_add_u32 m0, m0, 1024
s_add_u32 s45, s45, s44
buffer_load_dwordx4 v22, s[40:43], s45 offen nt lds
s_add_u32 m0, m0, 1024
s_add_u32 s45, s45, s44
buffer_load_dwordx4 v22, s[40:43], s45 offen nt lds
s_add_u32 m0, m0, 1024
s_add_u32 s45, s45, s44
s_sub_u32 s46, s46, 4
s_cmp_lg_u32 s46, 0
s_cbranch_scc1 L_FW_dma
s_cmp_eq_u32 s20, 2
s_cbranch_scc0 L_FW_mod
s_cmp_eq_u32 s38, 1
s_cbranch_scc0 L_FW_q1
s_barrier
s_waitcnt vmcnt(0) lgkmcnt(0)
s_endpgm
L_FW_q1:
s_cmp_eq_u32 s38, 2
s_cbranch_scc1 L_FW_q0
s_cmp_ge_u32 s30, 14
s_cbranch_scc0 L_FW_q0
s_mov_b32 s38, 2
s_branch L_FW_unit
L_FW_q0:
s_barrier
s_branch L_FW_prepQ
L_FW_mod:
s_waitcnt vmcnt(40)
v_lshlrev_b32 v24, 16, v18
v_and_b32 v25, 0xffff0000, v18
v_lshlrev_b32 v26, 16, v19
v_and_b32 v27, 0xffff0000, v19
v_lshlrev_b32 v28, 16, v20
v_and_b32 v29, 0xffff0000, v20
v_lshlrev_b32 v30, 16, v21
v_and_b32 v31, 0xffff0000, v21
v_mul_f32 v32, 0xbfb8aa3b, v24
v_mul_f32 v33, 0xbfb8aa3b, v25
v_mul_f32 v34, 0xbfb8aa3b, v26
v_mul_f32 v35, 0xbfb8aa3b, v27
v_mul_f32 v36, 0xbfb8aa3b, v28
v_mul_f32 v37, 0xbfb8aa3b, v29
v_mul_f32 v38, 0xbfb8aa3b, v30
v_mul_f32 v39, 0xbfb8aa3b, v31
v_exp_f32 v32, v32
v_exp_f32 v33, v33
v_exp_f32 v34, v34
v_exp_f32 v35, v35
v_exp_f32 v36, v36
v_exp_f32 v37, v37
v_exp_f32 v38, v38
v_exp_f32 v39, v39
v_add_f32 v32, 1.0, v32
v_add_f32 v33, 1.0, v33
v_add_f32 v34, 1.0, v34
v_add_f32 v35, 1.0, v35
v_add_f32 v36, 1.0, v36
v_add_f32 v37, 1.0, v37
v_add_f32 v38, 1.0, v38
v_add_f32 v39, 1.0, v39
v_rcp_f32 v32, v32
v_rcp_f32 v33, v33
v_rcp_f32 v34, v34
v_rcp_f32 v35, v35
v_rcp_f32 v36, v36
v_rcp_f32 v37, v37
v_rcp_f32 v38, v38
v_rcp_f32 v39, v39
v_mul_f32 v112, v24, v32
v_mul_f32 v113, v25, v33
v_mul_f32 v114, v26, v34
v_mul_f32 v115, v27, v35
v_mul_f32 v116, v28, v36
v_mul_f32 v117, v29, v37
v_mul_f32 v118, v30, v38
v_mul_f32 v119, v31, v39
s_mov_b32 exec_lo, -1
s_mov_b32 exec_hi, 0xff
s_branch L_FW_table
L_FW_prepQ:
s_waitcnt vmcnt(40)
v_lshlrev_b32 v24, 16, v8
v_and_b32 v25, 0xffff0000, v8
v_lshlrev_b32 v26, 16, v9
v_and_b32 v27, 0xffff0000, v9
v_lshlrev_b32 v28, 16, v10
v_and_b32 v29, 0xffff0000, v10
v_lshlrev_b32 v30, 16, v11
v_and_b32 v31, 0xffff0000, v11
v_lshlrev_b32 v32, 16, v12
v_and_b32 v33, 0xffff0000, v12
v_lshlrev_b32 v34, 16, v13
v_and_b32 v35, 0xffff0000, v13
v_lshlrev_b32 v36, 16, v14
v_and_b32 v37, 0xffff0000, v14
v_lshlrev_b32 v38, 16, v15
v_and_b32 v39, 0xffff0000, v15
v_lshlrev_b32 v40, 16, v16
v_and_b32 v41, 0xffff0000, v16
v_lshlrev_b32 v42, 16, v17
v_and_b32 v43, 0xffff0000, v17
v_pk_add_f32 v[44:45], v[24:25], v[26:27]
v_pk_add_f32 v[44:45], v[44:45], v[28:29]
v_pk_add_f32 v[44:45], v[44:45], v[30:31]
v_pk_add_f32 v[44:45], v[44:45], v[32:33]
v_pk_add_f32 v[44:45], v[44:45], v[34:35]
v_pk_add_f32 v[44:45], v[44:45], v[36:37]
v_pk_add_f32 v[44:45], v[44:45], v[38:39]
v_pk_add_f32 v[44:45], v[44:45], v[40:41]
v_pk_add_f32 v[44:45], v[44:45], v[42:43]
v_add_f32 v44, v44, v45
s_nop 1
v_add_f32_dpp v44, v44, v44 row_ror:8 row_mask:0xf bank_mask:0xf
s_nop 1
v_add_f32_dpp v44, v44, v44 row_ror:4 row_mask:0xf bank_mask:0xf
s_nop 1
v_add_f32_dpp v44, v44, v44 row_ror:2 row_mask:0xf bank_mask:0xf
s_nop 1
v_add_f32_dpp v44, v44, v44 row_ror:1 row_mask:0xf bank_mask:0xf
v_mov_b32 v45, v44
s_nop 1
v_permlane16_swap_b32 v44, v45
v_add_f32 v44, v44, v45
v_mul_f32 v44, 0x3acccccd, v44
v_sub_f32 v24, v24, v44
v_sub_f32 v25, v25, v44
v_sub_f32 v26, v26, v44
v_sub_f32 v27, v27, v44
v_sub_f32 v28, v28, v44
v_sub_f32 v29, v29, v44
v_sub_f32 v30, v30, v44
v_sub_f32 v31, v31, v44
v_sub_f32 v32, v32, v44
v_sub_f32 v33, v33, v44
v_sub_f32 v34, v34, v44
v_sub_f32 v35, v35, v44
v_sub_f32 v36, v36, v44
v_sub_f32 v37, v37, v44
v_sub_f32 v38, v38, v44
v_sub_f32 v39, v39, v44
v_sub_f32 v40, v40, v44
v_sub_f32 v41, v41, v44
v_sub_f32 v42, v42, v44
v_sub_f32 v43, v43, v44
v_pk_mul_f32 v[46:47], v[24:25], v[24:25]
v_pk_fma_f32 v[46:47], v[26:27], v[26:27], v[46:47]
v_pk_fma_f32 v[46:47], v[28:29], v[28:29], v[46:47]
v_pk_fma_f32 v[46:47], v[30:31], v[30:31], v[46:47]
v_pk_fma_f32 v[46:47], v[32:33], v[32:33], v[46:47]
v_pk_fma_f32 v[46:47], v[34:35], v[34:35], v[46:47]
v_pk_fma_f32 v[46:47], v[36:37], v[36:37], v[46:47]
v_pk_fma_f32 v[46:47], v[38:39], v[38:39], v[46:47]
v_pk_fma_f32 v[46:47], v[40:41], v[40:41], v[46:47]
v_pk_fma_f32 v[46:47], v[42:43], v[42:43], v[46:47]
v_add_f32 v46, v46, v47
s_nop 1
v_add_f32_dpp v46, v46, v46 row_ror:8 row_mask:0xf bank_mask:0xf
s_nop 1
v_add_f32_dpp v46, v46, v46 row_ror:4 row_mask:0xf bank_mask:0xf
s_nop 1
v_add_f32_dpp v46, v46, v46 row_ror:2 row_mask:0xf bank_mask:0xf
s_nop 1
v_add_f32_dpp v46, v46, v46 row_ror:1 row_mask:0xf bank_mask:0xf
v_mov_b32 v45, v46
s_nop 1
v_permlane16_swap_b32 v46, v45
v_add_f32 v46, v46, v45
v_mul_f32 v46, 0x3acccccd, v46
v_cvt_pk_bf16_f32 v44, v44, v44
v_and_b32 v44, 0xffff0000, v44
v_cvt_pk_bf16_f32 v46, v46, v46
v_and_b32 v46, 0xffff0000, v46
v_add_f32 v46, 0x3727c5ac, v46
v_cvt_pk_bf16_f32 v46, v46, v46
v_and_b32 v46, 0xffff0000, v46
v_sqrt_f32 v46, v46
s_nop 0
v_cvt_pk_bf16_f32 v46, v46, v46
v_and_b32 v46, 0xffff0000, v46
v_rcp_f32 v46, v46
v_readlane_b32 s48, v44, 0
v_readlane_b32 s49, v46, 0
v_readlane_b32 s50, v44, 32
v_readlane_b32 s51, v46, 32
s_waitcnt lgkmcnt(0)
s_add_u32 s7, s7, 1
s_and_b32 s8, s7, 0x7f
s_add_u32 s8, s8, 1
s_add_u32 s9, s8, 127
s_mul_i32 s33, s22, 160
v_lshlrev_b32 v2, 2, v0
v_add_u32 v2, s33, v2
v_lshrrev_b32 v3, 7, v2
v_lshlrev_b32 v3, 12, v3
v_and_b32 v2, 127, v2
v_lshlrev_b32 v2, 2, v2
v_add_u32 v2, v2, v3
v_add_u32 v2, 4096, v2
v_add_u32 v3, 20480, v2
s_mov_b32 exec_lo, -1
s_mov_b32 exec_hi, 0xff
v_lshlrev_b32 v24, 16, v18
v_and_b32 v25, 0xffff0000, v18
v_lshlrev_b32 v26, 16, v19
v_and_b32 v27, 0xffff0000, v19
v_lshlrev_b32 v28, 16, v20
v_and_b32 v29, 0xffff0000, v20
v_lshlrev_b32 v30, 16, v21
v_and_b32 v31, 0xffff0000, v21
v_subrev_f32 v24, s48, v24
v_subrev_f32 v25, s48, v25
v_subrev_f32 v26, s48, v26
v_subrev_f32 v27, s48, v27
v_subrev_f32 v28, s50, v28
v_subrev_f32 v29, s50, v29
v_subrev_f32 v30, s50, v30
v_subrev_f32 v31, s50, v31
v_cvt_pk_bf16_f32 v24, v24, v24
v_cvt_pk_bf16_f32 v25, v25, v25
v_cvt_pk_bf16_f32 v26, v26, v26
v_cvt_pk_bf16_f32 v27, v27, v27
v_cvt_pk_bf16_f32 v28, v28, v28
v_cvt_pk_bf16_f32 v29, v29, v29
v_cvt_pk_bf16_f32 v30, v30, v30
v_cvt_pk_bf16_f32 v31, v31, v31
v_and_b32 v24, 0xffff0000, v24
v_and_b32 v25, 0xffff0000, v25
v_and_b32 v26, 0xffff0000, v26
v_and_b32 v27, 0xffff0000, v27
v_and_b32 v28, 0xffff0000, v28
v_and_b32 v29, 0xffff0000, v29
v_and_b32 v30, 0xffff0000, v30
v_and_b32 v31, 0xffff0000, v31
v_mul_f32 v24, s49, v24
v_mul_f32 v25, s49, v25
v_mul_f32 v26, s49, v26
v_mul_f32 v27, s49, v27
v_mul_f32 v28, s51, v28
v_mul_f32 v29, s51, v29
v_mul_f32 v30, s51, v30
v_mul_f32 v31, s51, v31
v_cvt_pk_bf16_f32 v24, v24, v24
v_cvt_pk_bf16_f32 v25, v25, v25
v_cvt_pk_bf16_f32 v26, v26, v26
v_cvt_pk_bf16_f32 v27, v27, v27
v_cvt_pk_bf16_f32 v28, v28, v28
v_cvt_pk_bf16_f32 v29, v29, v29
v_cvt_pk_bf16_f32 v30, v30, v30
v_cvt_pk_bf16_f32 v31, v31, v31
v_and_b32 v24, 0xffff0000, v24
v_and_b32 v25, 0xffff0000, v25
v_and_b32 v26, 0xffff0000, v26
v_and_b32 v27, 0xffff0000, v27
v_and_b32 v28, 0xffff0000, v28
v_and_b32 v29, 0xffff0000, v29
v_and_b32 v30, 0xffff0000, v30
v_and_b32 v31, 0xffff0000, v31
L_FW_pollh:
buffer_load_dwordx4 v[48:51], v2, s[72:75], 0 offen offset:0 sc1
buffer_load_dwordx4 v[52:55], v2, s[72:75], 0 offen offset:1024 sc1
buffer_load_dwordx4 v[56:59], v2, s[72:75], 0 offen offset:2048 sc1
buffer_load_dwordx4 v[60:63], v2, s[72:75], 0 offen offset:3072 sc1
buffer_load_dwordx4 v[64:67], v2, s[72:75], 0 offen offset:512 sc1
buffer_load_dwordx4 v[68:71], v2, s[72:75], 0 offen offset:1536 sc1
buffer_load_dwordx4 v[72:75], v2, s[72:75], 0 offen offset:2560 sc1
buffer_load_dwordx4 v[76:79], v2, s[72:75], 0 offen offset:3584 sc1
buffer_load_dwordx4 v[80:83], v3, s[72:75], 0 offen offset:0 sc1
buffer_load_dwordx4 v[84:87], v3, s[72:75], 0 offen offset:1024 sc1
buffer_load_dwordx4 v[88:91], v3, s[72:75], 0 offen offset:2048 sc1
buffer_load_dwordx4 v[92:95], v3, s[72:75], 0 offen offset:3072 sc1
buffer_load_dwordx4 v[96:99], v3, s[72:75], 0 offen offset:512 sc1
buffer_load_dwordx4 v[100:103], v3, s[72:75], 0 offen offset:1536 sc1
buffer_load_dwordx4 v[104:107], v3, s[72:75], 0 offen offset:2560 sc1
buffer_load_dwordx4 v[108:111], v3, s[72:75], 0 offen offset:3584 sc1
s_waitcnt vmcnt(0)
v_msad_u8 v7, v48, s8, 0
v_msad_u8 v7, v49, s9, v7
v_msad_u8 v7, v50, s8, v7
v_msad_u8 v7, v51, s9, v7
v_msad_u8 v6, v80, s8, 0
v_msad_u8 v6, v81, s9, v6
v_msad_u8 v6, v82, s8, v6
v_msad_u8 v6, v83, s9, v6
v_msad_u8 v7, v52, s8, v7
v_msad_u8 v7, v53, s9, v7
v_msad_u8 v7, v54, s8, v7
v_msad_u8 v7, v55, s9, v7
v_msad_u8 v6, v84, s8, v6
v_msad_u8 v6, v85, s9, v6
v_msad_u8 v6, v86, s8, v6
v_msad_u8 v6, v87, s9, v6
v_msad_u8 v7, v56, s8, v7
v_msad_u8 v7, v57, s9, v7
v_msad_u8 v7, v58, s8, v7
v_msad_u8 v7, v59, s9, v7
v_msad_u8 v6, v88, s8, v6
v_msad_u8 v6, v89, s9, v6
v_msad_u8 v6, v90, s8, v6
v_msad_u8 v6, v91, s9, v6
v_msad_u8 v7, v60, s8, v7
v_msad_u8 v7, v61, s9, v7
v_msad_u8 v7, v62, s8, v7
v_msad_u8 v7, v63, s9, v7
v_msad_u8 v6, v92, s8, v6
v_msad_u8 v6, v93, s9, v6
v_msad_u8 v6, v94, s8, v6
v_msad_u8 v6, v95, s9, v6
v_msad_u8 v7, v64, s8, v7
v_msad_u8 v7, v65, s9, v7
v_msad_u8 v7, v66, s8, v7
v_msad_u8 v7, v67, s9, v7
v_msad_u8 v6, v96, s8, v6
v_msad_u8 v6, v97, s9, v6
v_msad_u8 v6, v98, s8, v6
v_msad_u8 v6, v99, s9, v6
v_msad_u8 v7, v68, s8, v7
v_msad_u8 v7, v69, s9, v7
v_msad_u8 v7, v70, s8, v7
v_msad_u8 v7, v71, s9, v7
v_msad_u8 v6, v100, s8, v6
v_msad_u8 v6, v101, s9, v6
v_msad_u8 v6, v102, s8, v6
v_msad_u8 v6, v103, s9, v6
v_msad_u8 v7, v72, s8, v7
v_msad_u8 v7, v73, s9, v7
v_msad_u8 v7, v74, s8, v7
v_msad_u8 v7, v75, s9, v7
v_msad_u8 v6, v104, s8, v6
v_msad_u8 v6, v105, s9, v6
v_msad_u8 v6, v106, s8, v6
v_msad_u8 v6, v107, s9, v6
v_msad_u8 v7, v76, s8, v7
v_msad_u8 v7, v77, s9, v7
v_msad_u8 v7, v78, s8, v7
v_msad_u8 v7, v79, s9, v7
v_msad_u8 v6, v108, s8, v6
v_msad_u8 v6, v109, s9, v6
v_msad_u8 v6, v110, s8, v6
v_msad_u8 v6, v111, s9, v6
v_or_b32 v7, v7, v6
v_cmp_ne_u32 vcc, 0, v7
s_nop 1
s_cbranch_vccz L_FW_pollh_ok
s_add_u32 s95, s95, 1
s_cmp_gt_u32 s95, 0x10000
s_cbranch_scc1 L_FW_pollh_ok
s_branch L_FW_pollh
L_FW_pollh_ok:
v_pk_add_f32 v[48:49], v[48:49], v[52:53]
v_pk_add_f32 v[50:51], v[50:51], v[54:55]
v_pk_add_f32 v[56:57], v[56:57], v[60:61]
v_pk_add_f32 v[58:59], v[58:59], v[62:63]
v_pk_add_f32 v[48:49], v[48:49], v[56:57]
v_pk_add_f32 v[50:51], v[50:51], v[58:59]
v_pk_add_f32 v[64:65], v[64:65], v[68:69]
v_pk_add_f32 v[66:67], v[66:67], v[70:71]
v_pk_add_f32 v[72:73], v[72:73], v[76:77]
v_pk_add_f32 v[74:75], v[74:75], v[78:79]
v_pk_add_f32 v[64:65], v[64:65], v[72:73]
v_pk_add_f32 v[66:67], v[66:67], v[74:75]
v_pk_add_f32 v[80:81], v[80:81], v[84:85]
v_pk_add_f32 v[82:83], v[82:83], v[86:87]
v_pk_add_f32 v[88:89], v[88:89], v[92:93]
v_pk_add_f32 v[90:91], v[90:91], v[94:95]
v_pk_add_f32 v[80:81], v[80:81], v[88:89]
v_pk_add_f32 v[82:83], v[82:83], v[90:91]
v_pk_add_f32 v[96:97], v[96:97], v[100:101]
v_pk_add_f32 v[98:99], v[98:99], v[102:103]
v_pk_add_f32 v[104:105], v[104:105], v[108:109]
v_pk_add_f32 v[106:107], v[106:107], v[110:111]
v_pk_add_f32 v[96:97], v[96:97], v[104:105]
v_pk_add_f32 v[98:99], v[98:99], v[106:107]
v_cvt_pk_bf16_f32 v48, v48, v48
v_cvt_pk_bf16_f32 v49, v49, v49
v_cvt_pk_bf16_f32 v50, v50, v50
v_cvt_pk_bf16_f32 v51, v51, v51
v_and_b32 v48, 0xffff0000, v48
v_and_b32 v49, 0xffff0000, v49
v_and_b32 v50, 0xffff0000, v50
v_and_b32 v51, 0xffff0000, v51
v_cvt_pk_bf16_f32 v64, v64, v64
v_cvt_pk_bf16_f32 v65, v65, v65
v_cvt_pk_bf16_f32 v66, v66, v66
v_cvt_pk_bf16_f32 v67, v67, v67
v_and_b32 v64, 0xffff0000, v64
v_and_b32 v65, 0xffff0000, v65
v_and_b32 v66, 0xffff0000, v66
v_and_b32 v67, 0xffff0000, v67
v_cvt_pk_bf16_f32 v80, v80, v80
v_cvt_pk_bf16_f32 v81, v81, v81
v_cvt_pk_bf16_f32 v82, v82, v82
v_cvt_pk_bf16_f32 v83, v83, v83
v_and_b32 v80, 0xffff0000, v80
v_and_b32 v81, 0xffff0000, v81
v_and_b32 v82, 0xffff0000, v82
v_and_b32 v83, 0xffff0000, v83
v_cvt_pk_bf16_f32 v96, v96, v96
v_cvt_pk_bf16_f32 v97, v97, v97
v_cvt_pk_bf16_f32 v98, v98, v98
v_cvt_pk_bf16_f32 v99, v99, v99
v_and_b32 v96, 0xffff0000, v96
v_and_b32 v97, 0xffff0000, v97
v_and_b32 v98, 0xffff0000, v98
v_and_b32 v99, 0xffff0000, v99
v_add_f32 v80, 1.0, v80
v_add_f32 v81, 1.0, v81
v_add_f32 v82, 1.0, v82
v_add_f32 v83, 1.0, v83
v_add_f32 v96, 1.0, v96
v_add_f32 v97, 1.0, v97
v_add_f32 v98, 1.0, v98
v_add_f32 v99, 1.0, v99
v_cvt_pk_bf16_f32 v80, v80, v80
v_cvt_pk_bf16_f32 v81, v81, v81
v_cvt_pk_bf16_f32 v82, v82, v82
v_cvt_pk_bf16_f32 v83, v83, v83
v_and_b32 v80, 0xffff0000, v80
v_and_b32 v81, 0xffff0000, v81
v_and_b32 v82, 0xffff0000, v82
v_and_b32 v83, 0xffff0000, v83
v_cvt_pk_bf16_f32 v96, v96, v96
v_cvt_pk_bf16_f32 v97, v97, v97
v_cvt_pk_bf16_f32 v98, v98, v98
v_cvt_pk_bf16_f32 v99, v99, v99
v_and_b32 v96, 0xffff0000, v96
v_and_b32 v97, 0xffff0000, v97
v_and_b32 v98, 0xffff0000, v98
v_and_b32 v99, 0xffff0000, v99
v_mul_f32 v24, v24, v80
v_mul_f32 v25, v25, v81
v_mul_f32 v26, v26, v82
v_mul_f32 v27, v27, v83
v_mul_f32 v28, v28, v96
v_mul_f32 v29, v29, v97
v_mul_f32 v30, v30, v98
v_mul_f32 v31, v31, v99
v_cvt_pk_bf16_f32 v24, v24, v24
v_cvt_pk_bf16_f32 v25, v25, v25
v_cvt_pk_bf16_f32 v26, v26, v26
v_cvt_pk_bf16_f32 v27, v27, v27
v_cvt_pk_bf16_f32 v28, v28, v28
v_cvt_pk_bf16_f32 v29, v29, v29
v_cvt_pk_bf16_f32 v30, v30, v30
v_cvt_pk_bf16_f32 v31, v31, v31
v_and_b32 v24, 0xffff0000, v24
v_and_b32 v25, 0xffff0000, v25
v_and_b32 v26, 0xffff0000, v26
v_and_b32 v27, 0xffff0000, v27
v_and_b32 v28, 0xffff0000, v28
v_and_b32 v29, 0xffff0000, v29
v_and_b32 v30, 0xffff0000, v30
v_and_b32 v31, 0xffff0000, v31
v_add_f32 v112, v24, v48
v_add_f32 v113, v25, v49
v_add_f32 v114, v26, v50
v_add_f32 v115, v27, v51
v_add_f32 v116, v28, v64
v_add_f32 v117, v29, v65
v_add_f32 v118, v30, v66
v_add_f32 v119, v31, v67
s_mov_b32 s24, 123904
L_FW_table:
v_cvt_pk_bf16_f32 v112, v112, v112
v_cvt_pk_bf16_f32 v113, v113, v113
v_cvt_pk_bf16_f32 v114, v114, v114
v_cvt_pk_bf16_f32 v115, v115, v115
v_cvt_pk_bf16_f32 v116, v116, v116
v_cvt_pk_bf16_f32 v117, v117, v117
v_cvt_pk_bf16_f32 v118, v118, v118
v_cvt_pk_bf16_f32 v119, v119, v119
v_lshlrev_b32 v2, 5, v0
v_add_u32 v2, s24, v2
ds_write2_b32 v2, v112, v113 offset0:0 offset1:2
ds_write2_b32 v2, v114, v115 offset0:4 offset1:6
ds_write2_b32 v2, v116, v117 offset0:1 offset1:3
ds_write2_b32 v2, v118, v119 offset0:5 offset1:7
s_mov_b64 exec, -1
s_waitcnt vmcnt(0) lgkmcnt(0)
s_cmp_eq_u32 s4, 9
s_cbranch_scc1 L_exit
s_cmp_eq_u32 s31, 1
s_cbranch_scc0 L_FW_qbar
s_cmp_eq_u32 s38, 0
s_cbranch_scc0 L_FW_mbar
s_barrier
s_barrier
s_barrier
s_mov_b32 s38, 2
s_branch L_FW_unit
L_FW_mbar:
s_add_u32 s7, s7, 1
s_and_b32 s8, s7, 0x7f
s_add_u32 s8, s8, 1
s_add_u32 s9, s8, 127
L_FW_mbar2:
s_barrier
s_barrier
s_barrier
s_barrier
s_branch L_F_gath
L_FW_qbar:
s_barrier
s_barrier
s_barrier
s_barrier
s_cmp_ge_u32 s30, 14
s_cbranch_scc0 L_F_gath
s_barrier
s_barrier
L_F_gath:
s_getpc_b64 s[56:57]
L_tp_2:
s_add_u32 s56, s56, L_table-L_tp_2
s_addc_u32 s57, s57, 0
s_lshr_b32 s53, s6, 1
s_lshl_b32 s53, s53, 2
s_mov_b32 s54, 0x4a
s_lshr_b32 s54, s54, s5
s_and_b32 s54, s54, 1
s_lshl_b32 s55, s54, 6
s_add_u32 s53, s53, s55
s_load_dword s52, s[56:57], s53
s_waitcnt lgkmcnt(0)
s_and_b32 s53, s6, 1
s_lshl_b32 s53, s53, 4
s_lshr_b32 s52, s52, s53
s_and_b32 s52, s52, 0xffff
s_and_b32 s33, s52, 7
s_lshr_b32 s34, s33, 2
s_and_b32 s33, s33, 3
s_mul_i32 s33, s33, 192
v_lshlrev_b32 v2, 2, v0
v_add_u32 v2, s33, v2
v_lshrrev_b32 v3, 7, v2
s_mul_i32 s33, s5, 6
v_add_u32 v3, s33, v3
v_lshlrev_b32 v3, 12, v3
v_and_b32 v2, 127, v2
v_lshlrev_b32 v2, 2, v2
s_lshl_b32 s34, s34, 9
s_add_u32 s34, s34, 131072
v_add3_u32 v8, v2, v3, s34
s_mov_b32 exec_lo, -1
s_mov_b32 exec_hi, 0xffff
L_F_q_poll:
buffer_load_dwordx4 v[16:19], v8, s[72:75], 0 offen offset:0 sc1
buffer_load_dwordx4 v[20:23], v8, s[72:75], 0 offen offset:1024 sc1
buffer_load_dwordx4 v[24:27], v8, s[72:75], 0 offen offset:2048 sc1
buffer_load_dwordx4 v[28:31], v8, s[72:75], 0 offen offset:3072 sc1
s_waitcnt vmcnt(0)
v_msad_u8 v7, v16, s8, 0
v_msad_u8 v7, v17, s9, v7
v_msad_u8 v7, v18, s8, v7
v_msad_u8 v7, v19, s9, v7
v_msad_u8 v7, v20, s8, v7
v_msad_u8 v7, v21, s9, v7
v_msad_u8 v7, v22, s8, v7
v_msad_u8 v7, v23, s9, v7
v_msad_u8 v7, v24, s8, v7
v_msad_u8 v7, v25, s9, v7
v_msad_u8 v7, v26, s8, v7
v_msad_u8 v7, v27, s9, v7
v_msad_u8 v7, v28, s8, v7
v_msad_u8 v7, v29, s9, v7
v_msad_u8 v7, v30, s8, v7
v_msad_u8 v7, v31, s9, v7
v_cmp_ne_u32 vcc, 0, v7
s_nop 1
s_cbranch_vccz L_F_q_poll_ok
s_add_u32 s95, s95, 1
s_cmp_gt_u32 s95, 0x10000
s_cbranch_scc1 L_F_q_poll_ok
s_sleep 1
s_branch L_F_q_poll
L_F_q_poll_ok:
v_add_f32 v16, v16, v20
v_add_f32 v24, v24, v28
v_add_f32 v17, v17, v21
v_add_f32 v25, v25, v29
v_add_f32 v18, v18, v22
v_add_f32 v26, v26, v30
v_add_f32 v19, v19, v23
v_add_f32 v27, v27, v31
v_add_f32 v16, v16, v24
v_add_f32 v17, v17, v25
v_add_f32 v18, v18, v26
v_add_f32 v19, v19, v27
v_cvt_pk_bf16_f32 v16, v16, v16
v_cvt_pk_bf16_f32 v17, v17, v17
v_cvt_pk_bf16_f32 v18, v18, v18
v_cvt_pk_bf16_f32 v19, v19, v19
v_and_b32 v16, 0xffff0000, v16
v_and_b32 v17, 0xffff0000, v17
v_and_b32 v18, 0xffff0000, v18
v_and_b32 v19, 0xffff0000, v19
s_mov_b32 s52, 0x07060302
v_perm_b32 v16, v17, v16, s52
v_perm_b32 v17, v19, v18, s52
v_lshlrev_b32 v2, 3, v0
v_add_u32 v2, 122880, v2
ds_write_b64 v2, v[16:17]
s_mov_b64 exec, 1
v_mov_b32 v2, 123480
v_mov_b32 v3, 1
s_waitcnt lgkmcnt(0)
ds_write_b32 v2, v3
s_waitcnt lgkmcnt(0)
L_exit:
s_endpgm
.p2align 6
L_table:
.long 0x05a800a0
.long 0x05a900a1
.long 0x05aa00a2
.long 0x05ab00a3
.long 0x05ac00a4
.long 0x048d0085
.long 0x0c9d0895
.long 0x048e0086
.long 0x0d780a70
.long 0x0d790a71
.long 0x08960a72
.long 0x00870c9e
.long 0x0897048f
.long 0x0d7a0c9f
.long 0x0d7b0a73
.long 0x0d7c0a74
.long 0x05a800a0
.long 0x05a900a1
.long 0x05aa00a2
.long 0x05ab00a3
.long 0x05ac00a4
.long 0x0e590e58
.long 0x048d0085
.long 0x0c9d0895
.long 0x0d7a0a72
.long 0x0d7b0a73
.long 0x0a900a74
.long 0x00860a91
.long 0x0896048e
.long 0x00870c9e
.long 0x0897048f
.long 0x0c9f0d7c
.section .rodata,"a"
.p2align 6
.amdhsa_kernel adaLN_cond__sliding_block_cached__geglu_ffn__decode_kernel
  .amdhsa_next_free_vgpr 168
  .amdhsa_next_free_sgpr 102
  .amdhsa_accum_offset 168
  .amdhsa_group_segment_fixed_size 0
  .amdhsa_kernarg_size 112
  .amdhsa_user_sgpr_count 2
  .amdhsa_user_sgpr_kernarg_segment_ptr 1
  .amdhsa_system_sgpr_workgroup_id_x 1
  .amdhsa_float_denorm_mode_32 3
.end_amdhsa_kernel
```
